```python
import torch

def _softmax(x, axis=-1):
    return torch.softmax(x, dim=axis)
def _gelu(x):
    return torch.nn.functional.gelu(x, approximate="tanh")
def _silu(x):
    return torch.nn.functional.silu(x)
def _sigmoid(x):
    return torch.sigmoid(x)
def _layernorm(x, axis=-1, eps=1e-5):
    m = x.mean(dim=axis, keepdim=True)
    v = x.var(dim=axis, keepdim=True, unbiased=False)
    return (x - m) / torch.sqrt(v + eps)
def _scatter_add(tgt, idx, src, axis=0):
    return tgt.clone().index_add_(axis, idx, src)
def _segment_sum(src, seg, n):
    out = torch.zeros((n,) + src.shape[1:], dtype=src.dtype)
    return out.index_add_(0, seg, src)
def _pad(x, pw):
    flat = tuple(v for pair in reversed(pw) for v in pair)
    return torch.nn.functional.pad(x, flat)

kernel_name = 'sequential_preLN__gqa_block_cached__swiglu_ffn__decode'

def setup_inputs():

    _w = (lambda a: (lambda t: t.to(torch.bfloat16) if t.is_floating_point() else t)(torch.as_tensor(a)))
    def _A_setup():
        B, Sq, D = 4, 1, 512
        Hq, Hkv, Sk, Dh = 32, 8, 4096, 128
        assert Hq % Hkv == 0, (Hq, Hkv)
        return {
            "x": _w((lambda *s: torch.randn(*s, dtype=torch.bfloat16) * 0.05)(B, Sq, D)),
            "k_cache": _w((lambda *s: torch.randn(*s, dtype=torch.bfloat16) * 3.2)(B, Hkv, Sk, Dh)),
            "v_cache": _w((lambda *s: torch.randn(*s, dtype=torch.bfloat16) * 0.4)(B, Hkv, Sk, Dh)),
            "wq": _w((lambda *s: torch.randn(*s, dtype=torch.bfloat16) * 3.2)(D, Hq * Dh) * (D ** -0.5)),
            "wo": _w((lambda *s: torch.randn(*s, dtype=torch.bfloat16) * 0.4)(Hq * Dh, D) * ((Hq * Dh) ** -0.5)),
        }
    _A_in = _A_setup()

    def _B_setup():
        B, S, D, F = 4, 1, 512, 1792
        return {
            "x": _w((lambda *s: torch.randn(*s, dtype=torch.bfloat16) * 0.05)(B, S, D)),
            "w_gate": _w((lambda *s: torch.randn(*s, dtype=torch.bfloat16) * 0.05)(D, F)),
            "w_up": _w((lambda *s: torch.randn(*s, dtype=torch.bfloat16) * 0.05)(D, F)),
            "w_down": _w((lambda *s: torch.randn(*s, dtype=torch.bfloat16) * 0.05)(F, D)),
        }
    _B_in = _B_setup()

    return {
        "A_x": _A_in["x"],
        "A_k_cache": _A_in["k_cache"],
        "A_v_cache": _A_in["v_cache"],
        "A_wq": _A_in["wq"],
        "A_wo": _A_in["wo"],
        "B_x": _B_in["x"],
        "B_w_gate": _B_in["w_gate"],
        "B_w_up": _B_in["w_up"],
        "B_w_down": _B_in["w_down"],
    }

def reference(A_x, A_k_cache, A_v_cache, A_wq, A_wo, B_x, B_w_gate, B_w_up, B_w_down):
    def _A_ref(x, k_cache, v_cache, wq, wo):
        B, Sq, D = x.shape
        Hq, Dh = 32, 128
        Hkv = k_cache.shape[1]
        rep = Hq // Hkv
        q = (lambda x, *d: x.permute(*d))((x @ wq).reshape(B, Sq, Hq, Dh), 0, 2, 1, 3)
        k = (lambda x, n, axis: torch.repeat_interleave(x, n, dim=axis))(k_cache, rep, axis=1)
        v = (lambda x, n, axis: torch.repeat_interleave(x, n, dim=axis))(v_cache, rep, axis=1)
        scores = torch.einsum("bhqd,bhkd->bhqk", q, k) * (Dh ** -0.5)
        p = _softmax(scores, axis=-1)
        o = torch.einsum("bhqk,bhkd->bhqd", p, v)
        return (lambda x, *d: x.permute(*d))(o, 0, 2, 1, 3).reshape(B, Sq, Hq * Dh) @ wo

    def _B_ref(x, w_gate, w_up, w_down):
        g = _silu(x @ w_gate)
        u = x @ w_up
        return (g * u) @ w_down

    x = A_x
    h = x + _A_ref(_layernorm(x, axis=-1), A_k_cache, A_v_cache, A_wq, A_wo)
    h2 = h + _B_ref(_layernorm(h, axis=-1), B_w_gate, B_w_up, B_w_down)
    return h2
```

```asm
; @launch grid=(256,1,1) block=(1024,1,1) lds=149504
.amdgcn_target "amdgcn-amd-amdhsa--gfx950"
.text
.globl sequential_preLN__gqa_block_cached__swiglu_ffn__decode_kernel
.p2align 8
.type sequential_preLN__gqa_block_cached__swiglu_ffn__decode_kernel,@function
sequential_preLN__gqa_block_cached__swiglu_ffn__decode_kernel:
    s_load_dwordx16 s[16:31], s[0:1], 0
    s_load_dwordx8 s[32:39], s[0:1], 64
    v_lshrrev_b32 v10, 6, v0
    s_cmp_ge_u32 s2, 256
    s_cbranch_scc1 L_end
    v_readfirstlane_b32 s3, v10
    v_and_b32 v1, 63, v0
    v_mov_b32 v0, 0
    s_sub_u32 s7, s3, 4
    s_cmp_ge_u32 s7, 11
    s_cbranch_scc1 L_fast
    s_cmp_lg_u32 s3, 4
    s_cbranch_scc1 L_noz
    v_lshlrev_b32 v12, 2, v1
    ds_write_b32 v12, v0
    s_waitcnt lgkmcnt(0)
L_noz:
    s_barrier
    s_sleep 8
    s_branch L_slow
L_fast:
    s_setprio 3
L_slow:
    s_and_b32 s4, s2, 7
    s_lshr_b32 s5, s2, 3
    s_lshr_b32 s72, s5, 3
    s_and_b32 s73, s5, 7
    s_cmp_eq_u32 s3, 15
    s_cbranch_scc1 L_hload
L_kvcalc:
    v_bfe_u32 v2, v1, 2, 2
    v_lshlrev_b32 v2, 8, v2
    v_lshrrev_b32 v10, 4, v1
    v_lshl_add_u32 v2, v10, 6, v2
    v_and_b32 v10, 3, v1
    v_lshl_add_u32 v2, v10, 4, v2
    s_lshl_b32 s13, s72, 3
    s_add_u32 s13, s13, s4
    s_lshl_b32 s13, s13, 20
    s_movk_i32 s14, 104
    s_cmp_lt_u32 s73, 2
    s_cselect_b32 s14, s14, 120
    s_cselect_b32 s15, 0, 4294967264
    s_cmp_lt_u32 s73, 4
    s_cselect_b32 s14, s14, 144
    s_cselect_b32 s15, s15, 4294967168
    s_mul_i32 s7, s14, s73
    s_add_u32 s15, s15, s7
    s_cmp_eq_u32 s5, 25
    s_cselect_b32 s7, 24, 0
    s_sub_u32 s14, s14, s7
    s_cmp_eq_u32 s5, 27
    s_cselect_b32 s7, 24, 0
    s_add_u32 s14, s14, s7
    s_lshr_b32 s7, s5, 1
    s_cmp_eq_u32 s7, 13
    s_cselect_b32 s7, 24, 0
    s_sub_u32 s15, s15, s7
    s_lshr_b32 s78, s14, 4
    s_and_b32 s14, s14, 15
    s_and_b32 s12, s3, 12
    s_mul_i32 s7, s78, s12
    s_add_u32 s15, s15, s7
    s_min_u32 s7, s12, s14
    s_add_u32 s15, s15, s7
    s_cmp_lt_u32 s3, s14
    s_addc_u32 s78, s78, 0
    s_lshl_b32 s14, s15, 10
    s_add_u32 s13, s13, s14
    s_lshl_b32 s42, s78, 12
    s_add_u32 s42, s42, s13
    s_and_b32 s7, s3, 3
    s_lshl_b32 s7, s7, 10
    s_add_u32 s13, s13, s7
    s_mov_b32 s43, 0x20000
    s_cmp_ge_u32 s3, 4
    s_cbranch_scc1 L_rest0
    v_lshrrev_b32 v11, 3, v1
    v_lshlrev_b32 v11, 13, v11
    v_and_b32 v12, 7, v1
    v_lshl_add_u32 v11, v12, 4, v11
    s_lshl_b32 s15, s4, 10
    s_lshl_b32 s7, s73, 7
    s_add_u32 s15, s15, s7
    s_lshl_b32 s7, s72, 20
    s_add_u32 s15, s15, s7
    s_lshl_b32 s7, s3, 18
    s_add_u32 s15, s15, s7
    s_lshl_b32 s7, s3, 12
    s_add_u32 s7, s7, 114688
    s_mov_b32 m0, s7
    s_mov_b32 s54, 0x400000
    s_mov_b32 s55, 0x20000
    s_waitcnt lgkmcnt(0)
    s_mov_b32 s52, s22
    s_mov_b32 s53, s23
    s_mov_b32 s40, s18
    s_mov_b32 s41, s19
    buffer_load_dwordx4 v11, s[52:55], s15 offen nt lds
    s_add_u32 m0, m0, 1024
    s_add_u32 s15, s15, 65536
    buffer_load_dwordx4 v11, s[52:55], s15 offen nt lds
    s_add_u32 m0, m0, 1024
    s_add_u32 s15, s15, 65536
    buffer_load_dwordx4 v11, s[52:55], s15 offen nt lds
    s_add_u32 m0, m0, 1024
    s_add_u32 s15, s15, 65536
    buffer_load_dwordx4 v11, s[52:55], s15 offen nt lds
    s_barrier
    buffer_load_dwordx4 v[16:19], v2, s[40:43], s13 offen nt
    s_add_u32 s14, s13, 4096
    buffer_load_dwordx4 v[20:23], v2, s[40:43], s14 offen nt
    s_add_u32 s14, s13, 8192
    buffer_load_dwordx4 v[24:27], v2, s[40:43], s14 offen nt
    s_add_u32 s14, s13, 12288
    buffer_load_dwordx4 v[28:31], v2, s[40:43], s14 offen nt
    s_add_u32 s14, s13, 16384
    buffer_load_dwordx4 v[32:35], v2, s[40:43], s14 offen nt
    s_add_u32 s14, s13, 20480
    buffer_load_dwordx4 v[36:39], v2, s[40:43], s14 offen nt
    s_add_u32 s14, s13, 24576
    buffer_load_dwordx4 v[40:43], v2, s[40:43], s14 offen nt
    s_add_u32 s14, s13, 28672
    buffer_load_dwordx4 v[44:47], v2, s[40:43], s14 offen nt
    s_add_u32 s14, s13, 32768
    buffer_load_dwordx4 v[48:51], v2, s[40:43], s14 offen nt
    v_mov_b32 v10, 1
    s_waitcnt vmcnt(9)
    s_mov_b64 exec, 1
    ds_add_u32 v0, v10 offset:28
    s_mov_b64 exec, -1
    v_lshlrev_b32 v3, 4, v1
    s_mov_b32 s44, s20
    s_mov_b32 s45, s21
    s_mov_b32 s46, s42
    s_mov_b32 s47, 0x20000
    buffer_load_dwordx4 v[56:59], v3, s[44:47], s13 offen nt
    s_add_u32 s14, s13, 4096
    buffer_load_dwordx4 v[60:63], v3, s[44:47], s14 offen nt
    s_add_u32 s14, s13, 8192
    buffer_load_dwordx4 v[64:67], v3, s[44:47], s14 offen nt
    s_add_u32 s14, s13, 12288
    buffer_load_dwordx4 v[68:71], v3, s[44:47], s14 offen nt
    s_add_u32 s14, s13, 16384
    buffer_load_dwordx4 v[72:75], v3, s[44:47], s14 offen nt
    s_add_u32 s14, s13, 20480
    buffer_load_dwordx4 v[76:79], v3, s[44:47], s14 offen nt
    s_add_u32 s14, s13, 24576
    buffer_load_dwordx4 v[80:83], v3, s[44:47], s14 offen nt
    s_add_u32 s14, s13, 28672
    buffer_load_dwordx4 v[84:87], v3, s[44:47], s14 offen nt
    s_add_u32 s14, s13, 32768
    buffer_load_dwordx4 v[88:91], v3, s[44:47], s14 offen nt
    s_branch L_rest
L_hload:
    s_setprio 3
    v_lshrrev_b32 v10, 4, v1
    v_lshlrev_b32 v10, 10, v10
    v_and_b32 v11, 15, v1
    v_lshl_add_u32 v10, v11, 4, v10
    s_lshl_b32 s74, s72, 8
    s_mov_b32 s62, 4096
    s_mov_b32 s63, 0x20000
    s_waitcnt lgkmcnt(0)
    s_load_dword s6, s[38:39], 0
    s_mov_b32 s60, s16
    s_mov_b32 s61, s17
    buffer_load_dwordx4 v[16:19], v10, s[60:63], 0 offen
    buffer_load_dwordx4 v[20:23], v10, s[60:63], 0 offen offset:256
    buffer_load_dwordx4 v[24:27], v10, s[60:63], 0 offen offset:512
    buffer_load_dwordx4 v[28:31], v10, s[60:63], 0 offen offset:768
    buffer_load_dwordx4 v[72:75], v10, s[60:63], s74 offen
    s_barrier
    s_branch L_kvcalc
L_rest0:
    s_cmp_eq_u32 s3, 15
    s_cbranch_scc1 L_rest1
    s_waitcnt lgkmcnt(0)
L_rest1:
    s_mov_b32 s40, s18
    s_mov_b32 s41, s19
L_rest:
    v_lshlrev_b32 v3, 4, v1
    v_mov_b32 v112, 0
    s_mov_b32 s65, 0x3fb8aa3b
    s_mov_b32 s66, 0x3db504f3
    s_mov_b32 s67, 0xffffff00
    s_mov_b32 s68, 0xffff0000
    s_mov_b32 s69, 0xbfb8aa3b
    s_getreg_b32 s79, hwreg(HW_REG_XCC_ID, 0, 4)
    s_mov_b32 s60, s16
    s_mov_b32 s61, s17
    s_mov_b32 s62, 0x1000
    s_mov_b32 s63, 0x20000
    s_mov_b32 s52, s22
    s_mov_b32 s53, s23
    s_mov_b32 s54, 0x400000
    s_mov_b32 s55, 0x20000
    s_mov_b32 s44, s20
    s_mov_b32 s45, s21
    s_mov_b32 s46, 0x2000000
    s_mov_b32 s47, 0x20000
    s_mov_b32 s48, s38
    s_mov_b32 s49, s39
    s_mov_b32 s50, 0x10000000
    s_mov_b32 s51, 0x20000
    s_cmp_eq_u32 s3, 15
    s_cbranch_scc1 L_helper
    s_load_dword s6, s[38:39], 0
    s_cmp_lt_u32 s3, 4
    s_cbranch_scc1 L_disp
    v_mov_b32 v100, 0
    v_mov_b32 v101, 0
    v_mov_b32 v102, 0
    v_mov_b32 v103, 0
    s_lshl_b32 s15, s4, 5
    s_add_u32 s15, s15, s5
    s_cmp_lt_u32 s3, 12
    s_cbranch_scc1 L_loads
    s_cmp_lg_u32 s3, 13
    s_cbranch_scc1 L_no13
    s_mov_b64 exec, 1
    buffer_load_dword v126, v0, s[44:47], s13 offen nt
    s_mov_b32 s54, 0x200000
    s_mov_b32 s52, s28
    s_mov_b32 s53, s29
    s_mov_b32 s54, 4096
    buffer_load_dword v126, v0, s[52:55], 0 offen
    s_mov_b32 s52, s30
    s_mov_b32 s53, s31
    buffer_load_dword v126, v0, s[52:55], 0 offen
    s_mov_b32 s52, s32
    s_mov_b32 s53, s33
    buffer_load_dword v126, v0, s[52:55], 0 offen
    s_mov_b32 s52, s34
    s_mov_b32 s53, s35
    buffer_load_dword v126, v0, s[52:55], 0 offen
    s_mov_b32 s52, s24
    s_mov_b32 s53, s25
    s_mov_b32 s54, 0x400000
    s_lshl_b32 s7, s4, 19
    buffer_load_dword v126, v0, s[52:55], s7 offen
    s_mov_b64 exec, -1
L_no13:
    s_cmp_lg_u32 s3, 14
    s_cbranch_scc1 L_loads
    v_lshlrev_b32 v10, 7, v1
    s_lshl_b32 s7, s15, 11
    s_add_u32 s7, s7, 131072
    s_mov_b64 exec, 0xffff
    buffer_load_dword v126, v10, s[48:51], s7 offen
    s_lshl_b32 s15, s15, 7
    s_add_u32 s15, s15, 32768
    s_mov_b64 exec, 1
    buffer_load_dword v127, v10, s[48:51], s15 offen
    s_lshl_b32 s15, s4, 13
    s_lshl_b32 s7, s5, 8
    s_add_u32 s15, s15, s7
    s_add_u32 s15, s15, 1703936
    s_mov_b64 exec, 3
    buffer_load_dword v127, v10, s[48:51], s15 offen
    s_add_u32 s15, s15, 65536
    buffer_load_dword v127, v10, s[48:51], s15 offen
    s_mov_b64 exec, -1
    s_branch L_loads
L_loads:
    s_mov_b32 s70, 0
L_lw0:
    ds_read_b32 v10, v0 offset:12
    s_add_u32 s70, s70, 1
    s_waitcnt lgkmcnt(0)
    v_readfirstlane_b32 s7, v10
    s_nop 0
    s_cmp_ge_u32 s7, 1
    s_cbranch_scc1 L_lwd0
    s_sleep 2
    s_cmp_lt_u32 s70, 262144
    s_cbranch_scc1 L_lw0
L_lwd0:
    s_setprio 2
    s_cmp_ge_u32 s3, 12
    s_cbranch_scc1 L_nogate
    s_setprio 1
    s_call_b64 s[76:77], L_wload
L_nogate:
    buffer_load_dwordx4 v[16:19], v2, s[40:43], s13 offen nt
    s_add_u32 s14, s13, 4096
    buffer_load_dwordx4 v[20:23], v2, s[40:43], s14 offen nt
    s_add_u32 s14, s13, 8192
    buffer_load_dwordx4 v[24:27], v2, s[40:43], s14 offen nt
    s_add_u32 s14, s13, 12288
    buffer_load_dwordx4 v[28:31], v2, s[40:43], s14 offen nt
    s_add_u32 s14, s13, 16384
    buffer_load_dwordx4 v[32:35], v2, s[40:43], s14 offen nt
    s_add_u32 s14, s13, 20480
    buffer_load_dwordx4 v[36:39], v2, s[40:43], s14 offen nt
    s_add_u32 s14, s13, 24576
    buffer_load_dwordx4 v[40:43], v2, s[40:43], s14 offen nt
    s_add_u32 s14, s13, 28672
    buffer_load_dwordx4 v[44:47], v2, s[40:43], s14 offen nt
    s_add_u32 s14, s13, 32768
    buffer_load_dwordx4 v[48:51], v2, s[40:43], s14 offen nt
L_disp:
    s_cmp_eq_u32 s78, 6
    s_cbranch_scc1 L_att6
    s_cmp_eq_u32 s78, 7
    s_cbranch_scc1 L_att7
    s_cmp_eq_u32 s78, 8
    s_cbranch_scc1 L_att8
    s_cmp_eq_u32 s78, 9
    s_cbranch_scc1 L_att9
L_att5:
    s_cmp_ge_u32 s3, 12
    s_cbranch_scc1 L_vskip5
    s_cmp_lt_u32 s3, 4
    s_cbranch_scc1 L_vq5
    s_setprio 1
    buffer_load_dwordx4 v[56:59], v3, s[44:47], s13 offen nt
    s_add_u32 s14, s13, 4096
    buffer_load_dwordx4 v[60:63], v3, s[44:47], s14 offen nt
    s_add_u32 s14, s13, 8192
    buffer_load_dwordx4 v[64:67], v3, s[44:47], s14 offen nt
    s_add_u32 s14, s13, 12288
    buffer_load_dwordx4 v[68:71], v3, s[44:47], s14 offen nt
    s_add_u32 s14, s13, 16384
    buffer_load_dwordx4 v[72:75], v3, s[44:47], s14 offen nt
    s_branch L_vtag5
L_vq5:
    s_setprio 3
    s_mov_b32 s70, 0
L_lw1:
    ds_read_b32 v10, v0 offset:4
    s_add_u32 s70, s70, 1
    s_waitcnt lgkmcnt(0)
    v_readfirstlane_b32 s7, v10
    s_nop 0
    s_cmp_eq_u32 s7, 1
    s_cbranch_scc1 L_lwd1
    s_sleep 1
    s_cmp_lt_u32 s70, 262144
    s_cbranch_scc1 L_lw1
L_lwd1:
    s_call_b64 s[76:77], L_qissue
    s_branch L_vdone5
L_vskip5:
    s_waitcnt vmcnt(0)
L_vtag5:
    s_waitcnt lgkmcnt(0)
    s_mov_b32 s64, s6
L_tagok5:
    s_mul_i32 s64, s64, 0x9E3779B1
    s_add_u32 s64, s64, 0x7F4A7C15
    s_and_b32 s8, s64, 0xff
    s_bfe_u32 s9, s64, 0x80008
    s_cmp_eq_u32 s8, s9
    s_cbranch_scc1 L_tagok5
    s_bfe_u32 s10, s64, 0x80010
    s_lshr_b32 s11, s64, 24
L_vdone5:
    s_mov_b32 s75, s3
    v_and_b32 v10, 1, v1
    v_lshlrev_b32 v10, 4, v10
    v_mov_b32 v11, 0xffff
    v_lshlrev_b32 v11, v10, v11
    v_and_b32 v10, 2, v1
    v_cmp_eq_u32 vcc, 0, v10
    s_nop 1
    v_cndmask_b32 v8, 0, v11, vcc
    v_cndmask_b32 v9, v11, 0, vcc
    v_lshlrev_b32 v2, 5, v1
    s_mov_b32 s70, 0
L_lw2:
    ds_read_b32 v10, v0 offset:0
    s_add_u32 s70, s70, 1
    s_waitcnt lgkmcnt(0)
    v_readfirstlane_b32 s71, v10
    s_nop 0
    s_and_b32 s7, s71, 0xff
    s_cmp_eq_u32 s7, 4
    s_cbranch_scc1 L_lwd2
    s_sleep 4
    s_cmp_lt_u32 s70, 262144
    s_cbranch_scc1 L_lw2
L_lwd2:
    s_setprio 2
    ds_read_b128 v[96:99], v2 offset:8192
    ds_read_b128 v[100:103], v2 offset:8208
    ds_read_b128 v[104:107], v2 offset:10240
    ds_read_b128 v[108:111], v2 offset:10256
    ds_read_b128 v[112:115], v2 offset:12288
    ds_read_b128 v[116:119], v2 offset:12304
    ds_read_b128 v[120:123], v2 offset:14336
    ds_read_b128 v[124:127], v2 offset:14352
    s_waitcnt lgkmcnt(0)
    v_pk_add_f32 v[96:97], v[96:97], v[104:105]
    v_pk_add_f32 v[112:113], v[112:113], v[120:121]
    v_pk_add_f32 v[98:99], v[98:99], v[106:107]
    v_pk_add_f32 v[114:115], v[114:115], v[122:123]
    v_pk_add_f32 v[100:101], v[100:101], v[108:109]
    v_pk_add_f32 v[116:117], v[116:117], v[124:125]
    v_pk_add_f32 v[102:103], v[102:103], v[110:111]
    v_pk_add_f32 v[118:119], v[118:119], v[126:127]
    v_pk_add_f32 v[96:97], v[96:97], v[112:113]
    v_pk_add_f32 v[98:99], v[98:99], v[114:115]
    v_pk_add_f32 v[100:101], v[100:101], v[116:117]
    v_pk_add_f32 v[102:103], v[102:103], v[118:119]
    v_cvt_pk_bf16_f32 v4, v96, v97
    v_cvt_pk_bf16_f32 v5, v98, v99
    v_cvt_pk_bf16_f32 v6, v100, v101
    v_cvt_pk_bf16_f32 v7, v102, v103
    s_waitcnt vmcnt(13)
    s_nop 0
    v_mfma_f32_16x16x32_bf16 v[12:15], v[16:19], v[4:7], 0
    s_waitcnt vmcnt(12)
    v_mfma_f32_16x16x32_bf16 v[16:19], v[20:23], v[4:7], 0
    s_waitcnt vmcnt(11)
    v_mfma_f32_16x16x32_bf16 v[20:23], v[24:27], v[4:7], 0
    s_waitcnt vmcnt(10)
    v_mfma_f32_16x16x32_bf16 v[24:27], v[28:31], v[4:7], 0
    s_waitcnt vmcnt(9)
    v_mfma_f32_16x16x32_bf16 v[28:31], v[32:35], v[4:7], 0
    v_mov_b32_dpp v96, v12 quad_perm:[0,0,0,0] row_mask:0xf bank_mask:0xf
    s_nop 0
    v_mov_b32_dpp v97, v16 quad_perm:[0,0,0,0] row_mask:0xf bank_mask:0xf
    s_nop 0
    v_mov_b32_dpp v98, v20 quad_perm:[0,0,0,0] row_mask:0xf bank_mask:0xf
    s_nop 0
    v_mov_b32_dpp v99, v24 quad_perm:[0,0,0,0] row_mask:0xf bank_mask:0xf
    s_nop 0
    v_mov_b32_dpp v100, v28 quad_perm:[0,0,0,0] row_mask:0xf bank_mask:0xf
    v_add_f32_dpp v96, v13, v96 quad_perm:[1,1,1,1] row_mask:0xf bank_mask:0xf
    v_add_f32_dpp v97, v17, v97 quad_perm:[1,1,1,1] row_mask:0xf bank_mask:0xf
    v_add_f32_dpp v98, v21, v98 quad_perm:[1,1,1,1] row_mask:0xf bank_mask:0xf
    v_add_f32_dpp v99, v25, v99 quad_perm:[1,1,1,1] row_mask:0xf bank_mask:0xf
    v_add_f32_dpp v100, v29, v100 quad_perm:[1,1,1,1] row_mask:0xf bank_mask:0xf
    v_add_f32_dpp v96, v14, v96 quad_perm:[2,2,2,2] row_mask:0xf bank_mask:0xf
    v_add_f32_dpp v97, v18, v97 quad_perm:[2,2,2,2] row_mask:0xf bank_mask:0xf
    v_add_f32_dpp v98, v22, v98 quad_perm:[2,2,2,2] row_mask:0xf bank_mask:0xf
    v_add_f32_dpp v99, v26, v99 quad_perm:[2,2,2,2] row_mask:0xf bank_mask:0xf
    v_add_f32_dpp v100, v30, v100 quad_perm:[2,2,2,2] row_mask:0xf bank_mask:0xf
    v_add_f32_dpp v96, v15, v96 quad_perm:[3,3,3,3] row_mask:0xf bank_mask:0xf
    v_add_f32_dpp v97, v19, v97 quad_perm:[3,3,3,3] row_mask:0xf bank_mask:0xf
    v_add_f32_dpp v98, v23, v98 quad_perm:[3,3,3,3] row_mask:0xf bank_mask:0xf
    v_add_f32_dpp v99, v27, v99 quad_perm:[3,3,3,3] row_mask:0xf bank_mask:0xf
    v_add_f32_dpp v100, v31, v100 quad_perm:[3,3,3,3] row_mask:0xf bank_mask:0xf
    v_cvt_pk_bf16_f32 v106, v96, v97
    v_cvt_pk_bf16_f32 v107, v98, v99
    v_cvt_pk_bf16_f32 v108, v100, v100
    v_lshlrev_b32 v96, 16, v106
    v_and_b32 v97, s68, v106
    v_lshlrev_b32 v98, 16, v107
    v_and_b32 v99, s68, v107
    v_lshlrev_b32 v100, 16, v108
    v_mul_f32 v96, s66, v96
    v_mul_f32 v97, s66, v97
    v_mul_f32 v98, s66, v98
    v_mul_f32 v99, s66, v99
    v_mul_f32 v100, s66, v100
    v_cvt_pk_bf16_f32 v106, v96, v97
    v_cvt_pk_bf16_f32 v107, v98, v99
    v_cvt_pk_bf16_f32 v108, v100, v100
    v_lshlrev_b32 v96, 16, v106
    v_and_b32 v97, s68, v106
    v_lshlrev_b32 v98, 16, v107
    v_and_b32 v99, s68, v107
    v_lshlrev_b32 v100, 16, v108
    v_max3_f32 v10, v96, v97, v98
    v_max3_f32 v10, v10, v99, v100
    v_mov_b32 v14, 0
    v_mov_b32 v15, 0
    v_mov_b32 v11, v10
    s_nop 1
    v_permlane16_swap_b32 v10, v11
    v_max_f32 v10, v10, v11
    v_mov_b32 v11, v10
    s_nop 1
    v_permlane32_swap_b32 v10, v11
    v_max_f32 v10, v10, v11
    v_mul_f32 v13, s69, v10
    v_fma_f32 v96, v96, s65, v13
    v_fma_f32 v97, v97, s65, v13
    v_fma_f32 v98, v98, s65, v13
    v_fma_f32 v99, v99, s65, v13
    v_fma_f32 v100, v100, s65, v13
    v_exp_f32 v96, v96
    v_mov_b32 v18, 0
    v_mov_b32 v19, 0
    v_exp_f32 v97, v97
    v_mov_b32 v22, 0
    v_mov_b32 v23, 0
    v_exp_f32 v98, v98
    v_mov_b32 v26, 0
    v_mov_b32 v27, 0
    v_exp_f32 v99, v99
    v_mov_b32 v30, 0
    v_mov_b32 v31, 0
    v_exp_f32 v100, v100
    v_mov_b32 v34, 0
    v_mov_b32 v35, 0
    v_cvt_pk_bf16_f32 v106, v96, v96
    v_cvt_pk_bf16_f32 v107, v97, v97
    v_cvt_pk_bf16_f32 v108, v98, v98
    v_cvt_pk_bf16_f32 v109, v99, v99
    v_cvt_pk_bf16_f32 v110, v100, v100
    v_add_f32 v96, v96, v97
    v_add_f32 v98, v98, v99
    v_add_f32 v96, v96, v98
    v_add_f32 v11, v96, v100
    v_mov_b32 v13, v11
    s_nop 1
    v_permlane16_swap_b32 v11, v13
    v_add_f32 v11, v11, v13
    v_mov_b32 v13, v11
    s_nop 1
    v_permlane32_swap_b32 v11, v13
    v_add_f32 v11, v11, v13
    v_bfe_u32 v13, v1, 2, 2
    v_lshlrev_b32 v13, 7, v13
    s_lshl_b32 s7, s3, 3
    v_add_u32 v13, s7, v13
    v_mov_b32 v125, 1
    s_mov_b64 exec, 0x1111
    ds_write_b64 v13, v[10:11] offset:256
    s_mov_b64 exec, 1
    ds_add_u32 v0, v125 offset:8
    s_mov_b64 exec, -1
    s_cmp_lt_u32 s3, 12
    s_cbranch_scc1 L_vl25
    s_setprio 1
    buffer_load_dwordx4 v[56:59], v3, s[44:47], s13 offen nt
    s_add_u32 s14, s13, 4096
    buffer_load_dwordx4 v[60:63], v3, s[44:47], s14 offen nt
    s_add_u32 s14, s13, 8192
    buffer_load_dwordx4 v[64:67], v3, s[44:47], s14 offen nt
    s_add_u32 s14, s13, 12288
    buffer_load_dwordx4 v[68:71], v3, s[44:47], s14 offen nt
    s_add_u32 s14, s13, 16384
    buffer_load_dwordx4 v[72:75], v3, s[44:47], s14 offen nt
L_vl25:
    v_and_b32 v16, v8, v106
    v_and_b32 v17, v9, v106
    v_and_b32 v20, v8, v107
    v_and_b32 v21, v9, v107
    v_and_b32 v24, v8, v108
    v_and_b32 v25, v9, v108
    v_and_b32 v28, v8, v109
    v_and_b32 v29, v9, v109
    v_and_b32 v32, v8, v110
    v_and_b32 v33, v9, v110
    s_lshl_b32 s7, s3, 11
    s_add_u32 s7, s7, 81920
    v_add_u32 v13, s7, v2
    s_cmp_ge_u32 s3, 12
    s_cselect_b32 s7, 20, 16
    v_mov_b32 v124, s7
    s_lshr_b32 s7, s3, 2
    s_cmp_eq_u32 s7, 2
    s_cselect_b32 s7, 0x100, 1
    v_mov_b32 v125, s7
    s_waitcnt vmcnt(4)
    v_mfma_f32_16x16x32_bf16 v[116:119], v[16:19], v[56:59], 0
    v_mfma_f32_16x16x32_bf16 v[120:123], v[14:17], v[56:59], 0
    s_waitcnt vmcnt(3)
    v_mfma_f32_16x16x32_bf16 v[116:119], v[20:23], v[60:63], v[116:119]
    v_mfma_f32_16x16x32_bf16 v[120:123], v[18:21], v[60:63], v[120:123]
    s_waitcnt vmcnt(2)
    v_mfma_f32_16x16x32_bf16 v[116:119], v[24:27], v[64:67], v[116:119]
    v_mfma_f32_16x16x32_bf16 v[120:123], v[22:25], v[64:67], v[120:123]
    s_waitcnt vmcnt(1)
    v_mfma_f32_16x16x32_bf16 v[116:119], v[28:31], v[68:71], v[116:119]
    v_mfma_f32_16x16x32_bf16 v[120:123], v[26:29], v[68:71], v[120:123]
    s_waitcnt vmcnt(0)
    v_mfma_f32_16x16x32_bf16 v[116:119], v[32:35], v[72:75], v[116:119]
    v_mfma_f32_16x16x32_bf16 v[120:123], v[30:33], v[72:75], v[120:123]
    s_nop 6
    ds_write_b128 v13, v[116:119]
    ds_write_b128 v13, v[120:123] offset:16
    s_mov_b64 exec, 1
    ds_add_u32 v124, v125
    s_branch L_b2
L_att6:
    s_cmp_ge_u32 s3, 12
    s_cbranch_scc1 L_vskip6
    s_cmp_lt_u32 s3, 4
    s_cbranch_scc1 L_vq6
    s_setprio 1
    buffer_load_dwordx4 v[56:59], v3, s[44:47], s13 offen nt
    s_add_u32 s14, s13, 4096
    buffer_load_dwordx4 v[60:63], v3, s[44:47], s14 offen nt
    s_add_u32 s14, s13, 8192
    buffer_load_dwordx4 v[64:67], v3, s[44:47], s14 offen nt
    s_add_u32 s14, s13, 12288
    buffer_load_dwordx4 v[68:71], v3, s[44:47], s14 offen nt
    s_add_u32 s14, s13, 16384
    buffer_load_dwordx4 v[72:75], v3, s[44:47], s14 offen nt
    s_add_u32 s14, s13, 20480
    buffer_load_dwordx4 v[76:79], v3, s[44:47], s14 offen nt
    s_branch L_vtag6
L_vq6:
    s_setprio 3
    s_mov_b32 s70, 0
L_lw3:
    ds_read_b32 v10, v0 offset:4
    s_add_u32 s70, s70, 1
    s_waitcnt lgkmcnt(0)
    v_readfirstlane_b32 s7, v10
    s_nop 0
    s_cmp_eq_u32 s7, 1
    s_cbranch_scc1 L_lwd3
    s_sleep 1
    s_cmp_lt_u32 s70, 262144
    s_cbranch_scc1 L_lw3
L_lwd3:
    s_call_b64 s[76:77], L_qissue
    s_branch L_vdone6
L_vskip6:
    s_waitcnt vmcnt(0)
L_vtag6:
    s_waitcnt lgkmcnt(0)
    s_mov_b32 s64, s6
L_tagok6:
    s_mul_i32 s64, s64, 0x9E3779B1
    s_add_u32 s64, s64, 0x7F4A7C15
    s_and_b32 s8, s64, 0xff
    s_bfe_u32 s9, s64, 0x80008
    s_cmp_eq_u32 s8, s9
    s_cbranch_scc1 L_tagok6
    s_bfe_u32 s10, s64, 0x80010
    s_lshr_b32 s11, s64, 24
L_vdone6:
    s_mov_b32 s75, s3
    v_and_b32 v10, 1, v1
    v_lshlrev_b32 v10, 4, v10
    v_mov_b32 v11, 0xffff
    v_lshlrev_b32 v11, v10, v11
    v_and_b32 v10, 2, v1
    v_cmp_eq_u32 vcc, 0, v10
    s_nop 1
    v_cndmask_b32 v8, 0, v11, vcc
    v_cndmask_b32 v9, v11, 0, vcc
    v_lshlrev_b32 v2, 5, v1
    s_mov_b32 s70, 0
L_lw4:
    ds_read_b32 v10, v0 offset:0
    s_add_u32 s70, s70, 1
    s_waitcnt lgkmcnt(0)
    v_readfirstlane_b32 s71, v10
    s_nop 0
    s_and_b32 s7, s71, 0xff
    s_cmp_eq_u32 s7, 4
    s_cbranch_scc1 L_lwd4
    s_sleep 4
    s_cmp_lt_u32 s70, 262144
    s_cbranch_scc1 L_lw4
L_lwd4:
    s_setprio 2
    ds_read_b128 v[96:99], v2 offset:8192
    ds_read_b128 v[100:103], v2 offset:8208
    ds_read_b128 v[104:107], v2 offset:10240
    ds_read_b128 v[108:111], v2 offset:10256
    ds_read_b128 v[112:115], v2 offset:12288
    ds_read_b128 v[116:119], v2 offset:12304
    ds_read_b128 v[120:123], v2 offset:14336
    ds_read_b128 v[124:127], v2 offset:14352
    s_waitcnt lgkmcnt(0)
    v_pk_add_f32 v[96:97], v[96:97], v[104:105]
    v_pk_add_f32 v[112:113], v[112:113], v[120:121]
    v_pk_add_f32 v[98:99], v[98:99], v[106:107]
    v_pk_add_f32 v[114:115], v[114:115], v[122:123]
    v_pk_add_f32 v[100:101], v[100:101], v[108:109]
    v_pk_add_f32 v[116:117], v[116:117], v[124:125]
    v_pk_add_f32 v[102:103], v[102:103], v[110:111]
    v_pk_add_f32 v[118:119], v[118:119], v[126:127]
    v_pk_add_f32 v[96:97], v[96:97], v[112:113]
    v_pk_add_f32 v[98:99], v[98:99], v[114:115]
    v_pk_add_f32 v[100:101], v[100:101], v[116:117]
    v_pk_add_f32 v[102:103], v[102:103], v[118:119]
    v_cvt_pk_bf16_f32 v4, v96, v97
    v_cvt_pk_bf16_f32 v5, v98, v99
    v_cvt_pk_bf16_f32 v6, v100, v101
    v_cvt_pk_bf16_f32 v7, v102, v103
    s_waitcnt vmcnt(14)
    s_nop 0
    v_mfma_f32_16x16x32_bf16 v[12:15], v[16:19], v[4:7], 0
    s_waitcnt vmcnt(13)
    v_mfma_f32_16x16x32_bf16 v[16:19], v[20:23], v[4:7], 0
    s_waitcnt vmcnt(12)
    v_mfma_f32_16x16x32_bf16 v[20:23], v[24:27], v[4:7], 0
    s_waitcnt vmcnt(11)
    v_mfma_f32_16x16x32_bf16 v[24:27], v[28:31], v[4:7], 0
    s_waitcnt vmcnt(10)
    v_mfma_f32_16x16x32_bf16 v[28:31], v[32:35], v[4:7], 0
    s_waitcnt vmcnt(9)
    v_mfma_f32_16x16x32_bf16 v[32:35], v[36:39], v[4:7], 0
    v_mov_b32_dpp v96, v12 quad_perm:[0,0,0,0] row_mask:0xf bank_mask:0xf
    v_mov_b32_dpp v97, v16 quad_perm:[0,0,0,0] row_mask:0xf bank_mask:0xf
    v_mov_b32_dpp v98, v20 quad_perm:[0,0,0,0] row_mask:0xf bank_mask:0xf
    s_nop 0
    v_mov_b32_dpp v99, v24 quad_perm:[0,0,0,0] row_mask:0xf bank_mask:0xf
    s_nop 0
    v_mov_b32_dpp v100, v28 quad_perm:[0,0,0,0] row_mask:0xf bank_mask:0xf
    s_nop 0
    v_mov_b32_dpp v101, v32 quad_perm:[0,0,0,0] row_mask:0xf bank_mask:0xf
    v_add_f32_dpp v96, v13, v96 quad_perm:[1,1,1,1] row_mask:0xf bank_mask:0xf
    v_add_f32_dpp v97, v17, v97 quad_perm:[1,1,1,1] row_mask:0xf bank_mask:0xf
    v_add_f32_dpp v98, v21, v98 quad_perm:[1,1,1,1] row_mask:0xf bank_mask:0xf
    v_add_f32_dpp v99, v25, v99 quad_perm:[1,1,1,1] row_mask:0xf bank_mask:0xf
    v_add_f32_dpp v100, v29, v100 quad_perm:[1,1,1,1] row_mask:0xf bank_mask:0xf
    v_add_f32_dpp v101, v33, v101 quad_perm:[1,1,1,1] row_mask:0xf bank_mask:0xf
    v_add_f32_dpp v96, v14, v96 quad_perm:[2,2,2,2] row_mask:0xf bank_mask:0xf
    v_add_f32_dpp v97, v18, v97 quad_perm:[2,2,2,2] row_mask:0xf bank_mask:0xf
    v_add_f32_dpp v98, v22, v98 quad_perm:[2,2,2,2] row_mask:0xf bank_mask:0xf
    v_add_f32_dpp v99, v26, v99 quad_perm:[2,2,2,2] row_mask:0xf bank_mask:0xf
    v_add_f32_dpp v100, v30, v100 quad_perm:[2,2,2,2] row_mask:0xf bank_mask:0xf
    v_add_f32_dpp v101, v34, v101 quad_perm:[2,2,2,2] row_mask:0xf bank_mask:0xf
    v_add_f32_dpp v96, v15, v96 quad_perm:[3,3,3,3] row_mask:0xf bank_mask:0xf
    v_add_f32_dpp v97, v19, v97 quad_perm:[3,3,3,3] row_mask:0xf bank_mask:0xf
    v_add_f32_dpp v98, v23, v98 quad_perm:[3,3,3,3] row_mask:0xf bank_mask:0xf
    v_add_f32_dpp v99, v27, v99 quad_perm:[3,3,3,3] row_mask:0xf bank_mask:0xf
    v_add_f32_dpp v100, v31, v100 quad_perm:[3,3,3,3] row_mask:0xf bank_mask:0xf
    v_add_f32_dpp v101, v35, v101 quad_perm:[3,3,3,3] row_mask:0xf bank_mask:0xf
    v_cvt_pk_bf16_f32 v106, v96, v97
    v_cvt_pk_bf16_f32 v107, v98, v99
    v_cvt_pk_bf16_f32 v108, v100, v101
    v_lshlrev_b32 v96, 16, v106
    v_and_b32 v97, s68, v106
    v_lshlrev_b32 v98, 16, v107
    v_and_b32 v99, s68, v107
    v_lshlrev_b32 v100, 16, v108
    v_and_b32 v101, s68, v108
    v_mul_f32 v96, s66, v96
    v_mul_f32 v97, s66, v97
    v_mul_f32 v98, s66, v98
    v_mul_f32 v99, s66, v99
    v_mul_f32 v100, s66, v100
    v_mul_f32 v101, s66, v101
    v_cvt_pk_bf16_f32 v106, v96, v97
    v_cvt_pk_bf16_f32 v107, v98, v99
    v_cvt_pk_bf16_f32 v108, v100, v101
    v_lshlrev_b32 v96, 16, v106
    v_and_b32 v97, s68, v106
    v_lshlrev_b32 v98, 16, v107
    v_and_b32 v99, s68, v107
    v_lshlrev_b32 v100, 16, v108
    v_and_b32 v101, s68, v108
    v_max3_f32 v10, v96, v97, v98
    v_max3_f32 v10, v10, v99, v100
    v_max_f32 v10, v10, v101
    v_mov_b32 v14, 0
    v_mov_b32 v15, 0
    v_mov_b32 v11, v10
    s_nop 1
    v_permlane16_swap_b32 v10, v11
    v_max_f32 v10, v10, v11
    v_mov_b32 v11, v10
    s_nop 1
    v_permlane32_swap_b32 v10, v11
    v_max_f32 v10, v10, v11
    v_mul_f32 v13, s69, v10
    v_fma_f32 v96, v96, s65, v13
    v_fma_f32 v97, v97, s65, v13
    v_fma_f32 v98, v98, s65, v13
    v_fma_f32 v99, v99, s65, v13
    v_fma_f32 v100, v100, s65, v13
    v_fma_f32 v101, v101, s65, v13
    v_exp_f32 v96, v96
    v_mov_b32 v18, 0
    v_mov_b32 v19, 0
    v_exp_f32 v97, v97
    v_mov_b32 v22, 0
    v_mov_b32 v23, 0
    v_exp_f32 v98, v98
    v_mov_b32 v26, 0
    v_mov_b32 v27, 0
    v_exp_f32 v99, v99
    v_mov_b32 v30, 0
    v_mov_b32 v31, 0
    v_exp_f32 v100, v100
    v_mov_b32 v34, 0
    v_mov_b32 v35, 0
    v_exp_f32 v101, v101
    v_mov_b32 v38, 0
    v_mov_b32 v39, 0
    v_cvt_pk_bf16_f32 v106, v96, v96
    v_cvt_pk_bf16_f32 v107, v97, v97
    v_cvt_pk_bf16_f32 v108, v98, v98
    v_cvt_pk_bf16_f32 v109, v99, v99
    v_cvt_pk_bf16_f32 v110, v100, v100
    v_cvt_pk_bf16_f32 v111, v101, v101
    v_add_f32 v96, v96, v97
    v_add_f32 v98, v98, v99
    v_add_f32 v100, v100, v101
    v_add_f32 v96, v96, v98
    v_add_f32 v11, v96, v100
    v_mov_b32 v13, v11
    s_nop 1
    v_permlane16_swap_b32 v11, v13
    v_add_f32 v11, v11, v13
    v_mov_b32 v13, v11
    s_nop 1
    v_permlane32_swap_b32 v11, v13
    v_add_f32 v11, v11, v13
    v_bfe_u32 v13, v1, 2, 2
    v_lshlrev_b32 v13, 7, v13
    s_lshl_b32 s7, s3, 3
    v_add_u32 v13, s7, v13
    v_mov_b32 v125, 1
    s_mov_b64 exec, 0x1111
    ds_write_b64 v13, v[10:11] offset:256
    s_mov_b64 exec, 1
    ds_add_u32 v0, v125 offset:8
    s_mov_b64 exec, -1
    s_cmp_lt_u32 s3, 12
    s_cbranch_scc1 L_vl26
    s_setprio 1
    buffer_load_dwordx4 v[56:59], v3, s[44:47], s13 offen nt
    s_add_u32 s14, s13, 4096
    buffer_load_dwordx4 v[60:63], v3, s[44:47], s14 offen nt
    s_add_u32 s14, s13, 8192
    buffer_load_dwordx4 v[64:67], v3, s[44:47], s14 offen nt
    s_add_u32 s14, s13, 12288
    buffer_load_dwordx4 v[68:71], v3, s[44:47], s14 offen nt
    s_add_u32 s14, s13, 16384
    buffer_load_dwordx4 v[72:75], v3, s[44:47], s14 offen nt
    s_add_u32 s14, s13, 20480
    buffer_load_dwordx4 v[76:79], v3, s[44:47], s14 offen nt
L_vl26:
    v_and_b32 v16, v8, v106
    v_and_b32 v17, v9, v106
    v_and_b32 v20, v8, v107
    v_and_b32 v21, v9, v107
    v_and_b32 v24, v8, v108
    v_and_b32 v25, v9, v108
    v_and_b32 v28, v8, v109
    v_and_b32 v29, v9, v109
    v_and_b32 v32, v8, v110
    v_and_b32 v33, v9, v110
    v_and_b32 v36, v8, v111
    v_and_b32 v37, v9, v111
    s_lshl_b32 s7, s3, 11
    s_add_u32 s7, s7, 81920
    v_add_u32 v13, s7, v2
    s_cmp_ge_u32 s3, 12
    s_cselect_b32 s7, 20, 16
    v_mov_b32 v124, s7
    s_lshr_b32 s7, s3, 2
    s_cmp_eq_u32 s7, 2
    s_cselect_b32 s7, 0x100, 1
    v_mov_b32 v125, s7
    s_waitcnt vmcnt(5)
    v_mfma_f32_16x16x32_bf16 v[116:119], v[16:19], v[56:59], 0
    v_mfma_f32_16x16x32_bf16 v[120:123], v[14:17], v[56:59], 0
    s_waitcnt vmcnt(4)
    v_mfma_f32_16x16x32_bf16 v[116:119], v[20:23], v[60:63], v[116:119]
    v_mfma_f32_16x16x32_bf16 v[120:123], v[18:21], v[60:63], v[120:123]
    s_waitcnt vmcnt(3)
    v_mfma_f32_16x16x32_bf16 v[116:119], v[24:27], v[64:67], v[116:119]
    v_mfma_f32_16x16x32_bf16 v[120:123], v[22:25], v[64:67], v[120:123]
    s_waitcnt vmcnt(2)
    v_mfma_f32_16x16x32_bf16 v[116:119], v[28:31], v[68:71], v[116:119]
    v_mfma_f32_16x16x32_bf16 v[120:123], v[26:29], v[68:71], v[120:123]
    s_waitcnt vmcnt(1)
    v_mfma_f32_16x16x32_bf16 v[116:119], v[32:35], v[72:75], v[116:119]
    v_mfma_f32_16x16x32_bf16 v[120:123], v[30:33], v[72:75], v[120:123]
    s_waitcnt vmcnt(0)
    v_mfma_f32_16x16x32_bf16 v[116:119], v[36:39], v[76:79], v[116:119]
    v_mfma_f32_16x16x32_bf16 v[120:123], v[34:37], v[76:79], v[120:123]
    s_nop 6
    ds_write_b128 v13, v[116:119]
    ds_write_b128 v13, v[120:123] offset:16
    s_mov_b64 exec, 1
    ds_add_u32 v124, v125
    s_branch L_b2
L_att7:
    s_cmp_ge_u32 s3, 12
    s_cbranch_scc1 L_vskip7
    s_cmp_lt_u32 s3, 4
    s_cbranch_scc1 L_vq7
    s_setprio 1
    buffer_load_dwordx4 v[56:59], v3, s[44:47], s13 offen nt
    s_add_u32 s14, s13, 4096
    buffer_load_dwordx4 v[60:63], v3, s[44:47], s14 offen nt
    s_add_u32 s14, s13, 8192
    buffer_load_dwordx4 v[64:67], v3, s[44:47], s14 offen nt
    s_add_u32 s14, s13, 12288
    buffer_load_dwordx4 v[68:71], v3, s[44:47], s14 offen nt
    s_add_u32 s14, s13, 16384
    buffer_load_dwordx4 v[72:75], v3, s[44:47], s14 offen nt
    s_add_u32 s14, s13, 20480
    buffer_load_dwordx4 v[76:79], v3, s[44:47], s14 offen nt
    s_add_u32 s14, s13, 24576
    buffer_load_dwordx4 v[80:83], v3, s[44:47], s14 offen nt
    s_branch L_vtag7
L_vq7:
    s_setprio 3
    s_mov_b32 s70, 0
L_lw5:
    ds_read_b32 v10, v0 offset:4
    s_add_u32 s70, s70, 1
    s_waitcnt lgkmcnt(0)
    v_readfirstlane_b32 s7, v10
    s_nop 0
    s_cmp_eq_u32 s7, 1
    s_cbranch_scc1 L_lwd5
    s_sleep 1
    s_cmp_lt_u32 s70, 262144
    s_cbranch_scc1 L_lw5
L_lwd5:
    s_call_b64 s[76:77], L_qissue
    s_branch L_vdone7
L_vskip7:
    s_waitcnt vmcnt(0)
L_vtag7:
    s_waitcnt lgkmcnt(0)
    s_mov_b32 s64, s6
L_tagok7:
    s_mul_i32 s64, s64, 0x9E3779B1
    s_add_u32 s64, s64, 0x7F4A7C15
    s_and_b32 s8, s64, 0xff
    s_bfe_u32 s9, s64, 0x80008
    s_cmp_eq_u32 s8, s9
    s_cbranch_scc1 L_tagok7
    s_bfe_u32 s10, s64, 0x80010
    s_lshr_b32 s11, s64, 24
L_vdone7:
    s_mov_b32 s75, s3
    v_and_b32 v10, 1, v1
    v_lshlrev_b32 v10, 4, v10
    v_mov_b32 v11, 0xffff
    v_lshlrev_b32 v11, v10, v11
    v_and_b32 v10, 2, v1
    v_cmp_eq_u32 vcc, 0, v10
    s_nop 1
    v_cndmask_b32 v8, 0, v11, vcc
    v_cndmask_b32 v9, v11, 0, vcc
    v_lshlrev_b32 v2, 5, v1
    s_mov_b32 s70, 0
L_lw6:
    ds_read_b32 v10, v0 offset:0
    s_add_u32 s70, s70, 1
    s_waitcnt lgkmcnt(0)
    v_readfirstlane_b32 s71, v10
    s_nop 0
    s_and_b32 s7, s71, 0xff
    s_cmp_eq_u32 s7, 4
    s_cbranch_scc1 L_lwd6
    s_sleep 4
    s_cmp_lt_u32 s70, 262144
    s_cbranch_scc1 L_lw6
L_lwd6:
    s_setprio 2
    ds_read_b128 v[96:99], v2 offset:8192
    ds_read_b128 v[100:103], v2 offset:8208
    ds_read_b128 v[104:107], v2 offset:10240
    ds_read_b128 v[108:111], v2 offset:10256
    ds_read_b128 v[112:115], v2 offset:12288
    ds_read_b128 v[116:119], v2 offset:12304
    ds_read_b128 v[120:123], v2 offset:14336
    ds_read_b128 v[124:127], v2 offset:14352
    s_waitcnt lgkmcnt(0)
    v_pk_add_f32 v[96:97], v[96:97], v[104:105]
    v_pk_add_f32 v[112:113], v[112:113], v[120:121]
    v_pk_add_f32 v[98:99], v[98:99], v[106:107]
    v_pk_add_f32 v[114:115], v[114:115], v[122:123]
    v_pk_add_f32 v[100:101], v[100:101], v[108:109]
    v_pk_add_f32 v[116:117], v[116:117], v[124:125]
    v_pk_add_f32 v[102:103], v[102:103], v[110:111]
    v_pk_add_f32 v[118:119], v[118:119], v[126:127]
    v_pk_add_f32 v[96:97], v[96:97], v[112:113]
    v_pk_add_f32 v[98:99], v[98:99], v[114:115]
    v_pk_add_f32 v[100:101], v[100:101], v[116:117]
    v_pk_add_f32 v[102:103], v[102:103], v[118:119]
    v_cvt_pk_bf16_f32 v4, v96, v97
    v_cvt_pk_bf16_f32 v5, v98, v99
    v_cvt_pk_bf16_f32 v6, v100, v101
    v_cvt_pk_bf16_f32 v7, v102, v103
    s_waitcnt vmcnt(15)
    s_nop 0
    v_mfma_f32_16x16x32_bf16 v[12:15], v[16:19], v[4:7], 0
    s_waitcnt vmcnt(14)
    v_mfma_f32_16x16x32_bf16 v[16:19], v[20:23], v[4:7], 0
    s_waitcnt vmcnt(13)
    v_mfma_f32_16x16x32_bf16 v[20:23], v[24:27], v[4:7], 0
    s_waitcnt vmcnt(12)
    v_mfma_f32_16x16x32_bf16 v[24:27], v[28:31], v[4:7], 0
    s_waitcnt vmcnt(11)
    v_mfma_f32_16x16x32_bf16 v[28:31], v[32:35], v[4:7], 0
    s_waitcnt vmcnt(10)
    v_mfma_f32_16x16x32_bf16 v[32:35], v[36:39], v[4:7], 0
    s_waitcnt vmcnt(9)
    v_mfma_f32_16x16x32_bf16 v[36:39], v[40:43], v[4:7], 0
    v_mov_b32_dpp v96, v12 quad_perm:[0,0,0,0] row_mask:0xf bank_mask:0xf
    v_mov_b32_dpp v97, v16 quad_perm:[0,0,0,0] row_mask:0xf bank_mask:0xf
    v_mov_b32_dpp v98, v20 quad_perm:[0,0,0,0] row_mask:0xf bank_mask:0xf
    v_mov_b32_dpp v99, v24 quad_perm:[0,0,0,0] row_mask:0xf bank_mask:0xf
    v_mov_b32_dpp v100, v28 quad_perm:[0,0,0,0] row_mask:0xf bank_mask:0xf
    s_nop 0
    v_mov_b32_dpp v101, v32 quad_perm:[0,0,0,0] row_mask:0xf bank_mask:0xf
    s_nop 0
    v_mov_b32_dpp v102, v36 quad_perm:[0,0,0,0] row_mask:0xf bank_mask:0xf
    v_add_f32_dpp v96, v13, v96 quad_perm:[1,1,1,1] row_mask:0xf bank_mask:0xf
    v_add_f32_dpp v97, v17, v97 quad_perm:[1,1,1,1] row_mask:0xf bank_mask:0xf
    v_add_f32_dpp v98, v21, v98 quad_perm:[1,1,1,1] row_mask:0xf bank_mask:0xf
    v_add_f32_dpp v99, v25, v99 quad_perm:[1,1,1,1] row_mask:0xf bank_mask:0xf
    v_add_f32_dpp v100, v29, v100 quad_perm:[1,1,1,1] row_mask:0xf bank_mask:0xf
    v_add_f32_dpp v101, v33, v101 quad_perm:[1,1,1,1] row_mask:0xf bank_mask:0xf
    v_add_f32_dpp v102, v37, v102 quad_perm:[1,1,1,1] row_mask:0xf bank_mask:0xf
    v_add_f32_dpp v96, v14, v96 quad_perm:[2,2,2,2] row_mask:0xf bank_mask:0xf
    v_add_f32_dpp v97, v18, v97 quad_perm:[2,2,2,2] row_mask:0xf bank_mask:0xf
    v_add_f32_dpp v98, v22, v98 quad_perm:[2,2,2,2] row_mask:0xf bank_mask:0xf
    v_add_f32_dpp v99, v26, v99 quad_perm:[2,2,2,2] row_mask:0xf bank_mask:0xf
    v_add_f32_dpp v100, v30, v100 quad_perm:[2,2,2,2] row_mask:0xf bank_mask:0xf
    v_add_f32_dpp v101, v34, v101 quad_perm:[2,2,2,2] row_mask:0xf bank_mask:0xf
    v_add_f32_dpp v102, v38, v102 quad_perm:[2,2,2,2] row_mask:0xf bank_mask:0xf
    v_add_f32_dpp v96, v15, v96 quad_perm:[3,3,3,3] row_mask:0xf bank_mask:0xf
    v_add_f32_dpp v97, v19, v97 quad_perm:[3,3,3,3] row_mask:0xf bank_mask:0xf
    v_add_f32_dpp v98, v23, v98 quad_perm:[3,3,3,3] row_mask:0xf bank_mask:0xf
    v_add_f32_dpp v99, v27, v99 quad_perm:[3,3,3,3] row_mask:0xf bank_mask:0xf
    v_add_f32_dpp v100, v31, v100 quad_perm:[3,3,3,3] row_mask:0xf bank_mask:0xf
    v_add_f32_dpp v101, v35, v101 quad_perm:[3,3,3,3] row_mask:0xf bank_mask:0xf
    v_add_f32_dpp v102, v39, v102 quad_perm:[3,3,3,3] row_mask:0xf bank_mask:0xf
    v_cvt_pk_bf16_f32 v106, v96, v97
    v_cvt_pk_bf16_f32 v107, v98, v99
    v_cvt_pk_bf16_f32 v108, v100, v101
    v_cvt_pk_bf16_f32 v109, v102, v102
    v_lshlrev_b32 v96, 16, v106
    v_and_b32 v97, s68, v106
    v_lshlrev_b32 v98, 16, v107
    v_and_b32 v99, s68, v107
    v_lshlrev_b32 v100, 16, v108
    v_and_b32 v101, s68, v108
    v_lshlrev_b32 v102, 16, v109
    v_mul_f32 v96, s66, v96
    v_mul_f32 v97, s66, v97
    v_mul_f32 v98, s66, v98
    v_mul_f32 v99, s66, v99
    v_mul_f32 v100, s66, v100
    v_mul_f32 v101, s66, v101
    v_mul_f32 v102, s66, v102
    v_cvt_pk_bf16_f32 v106, v96, v97
    v_cvt_pk_bf16_f32 v107, v98, v99
    v_cvt_pk_bf16_f32 v108, v100, v101
    v_cvt_pk_bf16_f32 v109, v102, v102
    v_lshlrev_b32 v96, 16, v106
    v_and_b32 v97, s68, v106
    v_lshlrev_b32 v98, 16, v107
    v_and_b32 v99, s68, v107
    v_lshlrev_b32 v100, 16, v108
    v_and_b32 v101, s68, v108
    v_lshlrev_b32 v102, 16, v109
    v_max3_f32 v10, v96, v97, v98
    v_max3_f32 v10, v10, v99, v100
    v_max3_f32 v10, v10, v101, v102
    v_mov_b32 v14, 0
    v_mov_b32 v15, 0
    v_mov_b32 v11, v10
    s_nop 1
    v_permlane16_swap_b32 v10, v11
    v_max_f32 v10, v10, v11
    v_mov_b32 v11, v10
    s_nop 1
    v_permlane32_swap_b32 v10, v11
    v_max_f32 v10, v10, v11
    v_mul_f32 v13, s69, v10
    v_fma_f32 v96, v96, s65, v13
    v_fma_f32 v97, v97, s65, v13
    v_fma_f32 v98, v98, s65, v13
    v_fma_f32 v99, v99, s65, v13
    v_fma_f32 v100, v100, s65, v13
    v_fma_f32 v101, v101, s65, v13
    v_fma_f32 v102, v102, s65, v13
    v_exp_f32 v96, v96
    v_mov_b32 v18, 0
    v_mov_b32 v19, 0
    v_exp_f32 v97, v97
    v_mov_b32 v22, 0
    v_mov_b32 v23, 0
    v_exp_f32 v98, v98
    v_mov_b32 v26, 0
    v_mov_b32 v27, 0
    v_exp_f32 v99, v99
    v_mov_b32 v30, 0
    v_mov_b32 v31, 0
    v_exp_f32 v100, v100
    v_mov_b32 v34, 0
    v_mov_b32 v35, 0
    v_exp_f32 v101, v101
    v_mov_b32 v38, 0
    v_mov_b32 v39, 0
    v_exp_f32 v102, v102
    v_mov_b32 v42, 0
    v_mov_b32 v43, 0
    v_cvt_pk_bf16_f32 v106, v96, v96
    v_cvt_pk_bf16_f32 v107, v97, v97
    v_cvt_pk_bf16_f32 v108, v98, v98
    v_cvt_pk_bf16_f32 v109, v99, v99
    v_cvt_pk_bf16_f32 v110, v100, v100
    v_cvt_pk_bf16_f32 v111, v101, v101
    v_cvt_pk_bf16_f32 v112, v102, v102
    v_add_f32 v96, v96, v97
    v_add_f32 v98, v98, v99
    v_add_f32 v100, v100, v101
    v_add_f32 v96, v96, v98
    v_add_f32 v100, v100, v102
    v_add_f32 v11, v96, v100
    v_mov_b32 v13, v11
    s_nop 1
    v_permlane16_swap_b32 v11, v13
    v_add_f32 v11, v11, v13
    v_mov_b32 v13, v11
    s_nop 1
    v_permlane32_swap_b32 v11, v13
    v_add_f32 v11, v11, v13
    v_bfe_u32 v13, v1, 2, 2
    v_lshlrev_b32 v13, 7, v13
    s_lshl_b32 s7, s3, 3
    v_add_u32 v13, s7, v13
    v_mov_b32 v125, 1
    s_mov_b64 exec, 0x1111
    ds_write_b64 v13, v[10:11] offset:256
    s_mov_b64 exec, 1
    ds_add_u32 v0, v125 offset:8
    s_mov_b64 exec, -1
    s_cmp_lt_u32 s3, 12
    s_cbranch_scc1 L_vl27
    s_setprio 1
    buffer_load_dwordx4 v[56:59], v3, s[44:47], s13 offen nt
    s_add_u32 s14, s13, 4096
    buffer_load_dwordx4 v[60:63], v3, s[44:47], s14 offen nt
    s_add_u32 s14, s13, 8192
    buffer_load_dwordx4 v[64:67], v3, s[44:47], s14 offen nt
    s_add_u32 s14, s13, 12288
    buffer_load_dwordx4 v[68:71], v3, s[44:47], s14 offen nt
    s_add_u32 s14, s13, 16384
    buffer_load_dwordx4 v[72:75], v3, s[44:47], s14 offen nt
    s_add_u32 s14, s13, 20480
    buffer_load_dwordx4 v[76:79], v3, s[44:47], s14 offen nt
    s_add_u32 s14, s13, 24576
    buffer_load_dwordx4 v[80:83], v3, s[44:47], s14 offen nt
L_vl27:
    v_and_b32 v16, v8, v106
    v_and_b32 v17, v9, v106
    v_and_b32 v20, v8, v107
    v_and_b32 v21, v9, v107
    v_and_b32 v24, v8, v108
    v_and_b32 v25, v9, v108
    v_and_b32 v28, v8, v109
    v_and_b32 v29, v9, v109
    v_and_b32 v32, v8, v110
    v_and_b32 v33, v9, v110
    v_and_b32 v36, v8, v111
    v_and_b32 v37, v9, v111
    v_and_b32 v40, v8, v112
    v_and_b32 v41, v9, v112
    s_lshl_b32 s7, s3, 11
    s_add_u32 s7, s7, 81920
    v_add_u32 v13, s7, v2
    s_cmp_ge_u32 s3, 12
    s_cselect_b32 s7, 20, 16
    v_mov_b32 v124, s7
    s_lshr_b32 s7, s3, 2
    s_cmp_eq_u32 s7, 2
    s_cselect_b32 s7, 0x100, 1
    v_mov_b32 v125, s7
    s_waitcnt vmcnt(6)
    v_mfma_f32_16x16x32_bf16 v[116:119], v[16:19], v[56:59], 0
    v_mfma_f32_16x16x32_bf16 v[120:123], v[14:17], v[56:59], 0
    s_waitcnt vmcnt(5)
    v_mfma_f32_16x16x32_bf16 v[116:119], v[20:23], v[60:63], v[116:119]
    v_mfma_f32_16x16x32_bf16 v[120:123], v[18:21], v[60:63], v[120:123]
    s_waitcnt vmcnt(4)
    v_mfma_f32_16x16x32_bf16 v[116:119], v[24:27], v[64:67], v[116:119]
    v_mfma_f32_16x16x32_bf16 v[120:123], v[22:25], v[64:67], v[120:123]
    s_waitcnt vmcnt(3)
    v_mfma_f32_16x16x32_bf16 v[116:119], v[28:31], v[68:71], v[116:119]
    v_mfma_f32_16x16x32_bf16 v[120:123], v[26:29], v[68:71], v[120:123]
    s_waitcnt vmcnt(2)
    v_mfma_f32_16x16x32_bf16 v[116:119], v[32:35], v[72:75], v[116:119]
    v_mfma_f32_16x16x32_bf16 v[120:123], v[30:33], v[72:75], v[120:123]
    s_waitcnt vmcnt(1)
    v_mfma_f32_16x16x32_bf16 v[116:119], v[36:39], v[76:79], v[116:119]
    v_mfma_f32_16x16x32_bf16 v[120:123], v[34:37], v[76:79], v[120:123]
    s_waitcnt vmcnt(0)
    v_mfma_f32_16x16x32_bf16 v[116:119], v[40:43], v[80:83], v[116:119]
    v_mfma_f32_16x16x32_bf16 v[120:123], v[38:41], v[80:83], v[120:123]
    s_nop 6
    ds_write_b128 v13, v[116:119]
    ds_write_b128 v13, v[120:123] offset:16
    s_mov_b64 exec, 1
    ds_add_u32 v124, v125
    s_branch L_b2
L_att8:
    s_cmp_ge_u32 s3, 12
    s_cbranch_scc1 L_vskip8
    s_cmp_lt_u32 s3, 4
    s_cbranch_scc1 L_vq8
    s_setprio 1
    buffer_load_dwordx4 v[56:59], v3, s[44:47], s13 offen nt
    s_add_u32 s14, s13, 4096
    buffer_load_dwordx4 v[60:63], v3, s[44:47], s14 offen nt
    s_add_u32 s14, s13, 8192
    buffer_load_dwordx4 v[64:67], v3, s[44:47], s14 offen nt
    s_add_u32 s14, s13, 12288
    buffer_load_dwordx4 v[68:71], v3, s[44:47], s14 offen nt
    s_add_u32 s14, s13, 16384
    buffer_load_dwordx4 v[72:75], v3, s[44:47], s14 offen nt
    s_add_u32 s14, s13, 20480
    buffer_load_dwordx4 v[76:79], v3, s[44:47], s14 offen nt
    s_add_u32 s14, s13, 24576
    buffer_load_dwordx4 v[80:83], v3, s[44:47], s14 offen nt
    s_add_u32 s14, s13, 28672
    buffer_load_dwordx4 v[84:87], v3, s[44:47], s14 offen nt
    s_branch L_vtag8
L_vq8:
    s_setprio 3
    s_mov_b32 s70, 0
L_lw7:
    ds_read_b32 v10, v0 offset:4
    s_add_u32 s70, s70, 1
    s_waitcnt lgkmcnt(0)
    v_readfirstlane_b32 s7, v10
    s_nop 0
    s_cmp_eq_u32 s7, 1
    s_cbranch_scc1 L_lwd7
    s_sleep 1
    s_cmp_lt_u32 s70, 262144
    s_cbranch_scc1 L_lw7
L_lwd7:
    s_call_b64 s[76:77], L_qissue
    s_branch L_vdone8
L_vskip8:
    s_waitcnt vmcnt(0)
L_vtag8:
    s_waitcnt lgkmcnt(0)
    s_mov_b32 s64, s6
L_tagok8:
    s_mul_i32 s64, s64, 0x9E3779B1
    s_add_u32 s64, s64, 0x7F4A7C15
    s_and_b32 s8, s64, 0xff
    s_bfe_u32 s9, s64, 0x80008
    s_cmp_eq_u32 s8, s9
    s_cbranch_scc1 L_tagok8
    s_bfe_u32 s10, s64, 0x80010
    s_lshr_b32 s11, s64, 24
L_vdone8:
    s_mov_b32 s75, s3
    v_and_b32 v10, 1, v1
    v_lshlrev_b32 v10, 4, v10
    v_mov_b32 v11, 0xffff
    v_lshlrev_b32 v11, v10, v11
    v_and_b32 v10, 2, v1
    v_cmp_eq_u32 vcc, 0, v10
    s_nop 1
    v_cndmask_b32 v8, 0, v11, vcc
    v_cndmask_b32 v9, v11, 0, vcc
    v_lshlrev_b32 v2, 5, v1
    s_mov_b32 s70, 0
L_lw8:
    ds_read_b32 v10, v0 offset:0
    s_add_u32 s70, s70, 1
    s_waitcnt lgkmcnt(0)
    v_readfirstlane_b32 s71, v10
    s_nop 0
    s_and_b32 s7, s71, 0xff
    s_cmp_eq_u32 s7, 4
    s_cbranch_scc1 L_lwd8
    s_sleep 4
    s_cmp_lt_u32 s70, 262144
    s_cbranch_scc1 L_lw8
L_lwd8:
    s_setprio 2
    ds_read_b128 v[96:99], v2 offset:8192
    ds_read_b128 v[100:103], v2 offset:8208
    ds_read_b128 v[104:107], v2 offset:10240
    ds_read_b128 v[108:111], v2 offset:10256
    ds_read_b128 v[112:115], v2 offset:12288
    ds_read_b128 v[116:119], v2 offset:12304
    ds_read_b128 v[120:123], v2 offset:14336
    ds_read_b128 v[124:127], v2 offset:14352
    s_waitcnt lgkmcnt(0)
    v_pk_add_f32 v[96:97], v[96:97], v[104:105]
    v_pk_add_f32 v[112:113], v[112:113], v[120:121]
    v_pk_add_f32 v[98:99], v[98:99], v[106:107]
    v_pk_add_f32 v[114:115], v[114:115], v[122:123]
    v_pk_add_f32 v[100:101], v[100:101], v[108:109]
    v_pk_add_f32 v[116:117], v[116:117], v[124:125]
    v_pk_add_f32 v[102:103], v[102:103], v[110:111]
    v_pk_add_f32 v[118:119], v[118:119], v[126:127]
    v_pk_add_f32 v[96:97], v[96:97], v[112:113]
    v_pk_add_f32 v[98:99], v[98:99], v[114:115]
    v_pk_add_f32 v[100:101], v[100:101], v[116:117]
    v_pk_add_f32 v[102:103], v[102:103], v[118:119]
    v_cvt_pk_bf16_f32 v4, v96, v97
    v_cvt_pk_bf16_f32 v5, v98, v99
    v_cvt_pk_bf16_f32 v6, v100, v101
    v_cvt_pk_bf16_f32 v7, v102, v103
    s_waitcnt vmcnt(16)
    s_nop 0
    v_mfma_f32_16x16x32_bf16 v[12:15], v[16:19], v[4:7], 0
    s_waitcnt vmcnt(15)
    v_mfma_f32_16x16x32_bf16 v[16:19], v[20:23], v[4:7], 0
    s_waitcnt vmcnt(14)
    v_mfma_f32_16x16x32_bf16 v[20:23], v[24:27], v[4:7], 0
    s_waitcnt vmcnt(13)
    v_mfma_f32_16x16x32_bf16 v[24:27], v[28:31], v[4:7], 0
    s_waitcnt vmcnt(12)
    v_mfma_f32_16x16x32_bf16 v[28:31], v[32:35], v[4:7], 0
    s_waitcnt vmcnt(11)
    v_mfma_f32_16x16x32_bf16 v[32:35], v[36:39], v[4:7], 0
    s_waitcnt vmcnt(10)
    v_mfma_f32_16x16x32_bf16 v[36:39], v[40:43], v[4:7], 0
    s_waitcnt vmcnt(9)
    v_mfma_f32_16x16x32_bf16 v[40:43], v[44:47], v[4:7], 0
    v_mov_b32_dpp v96, v12 quad_perm:[0,0,0,0] row_mask:0xf bank_mask:0xf
    v_mov_b32_dpp v97, v16 quad_perm:[0,0,0,0] row_mask:0xf bank_mask:0xf
    v_mov_b32_dpp v98, v20 quad_perm:[0,0,0,0] row_mask:0xf bank_mask:0xf
    v_mov_b32_dpp v99, v24 quad_perm:[0,0,0,0] row_mask:0xf bank_mask:0xf
    v_mov_b32_dpp v100, v28 quad_perm:[0,0,0,0] row_mask:0xf bank_mask:0xf
    v_mov_b32_dpp v101, v32 quad_perm:[0,0,0,0] row_mask:0xf bank_mask:0xf
    v_mov_b32_dpp v102, v36 quad_perm:[0,0,0,0] row_mask:0xf bank_mask:0xf
    s_nop 0
    v_mov_b32_dpp v103, v40 quad_perm:[0,0,0,0] row_mask:0xf bank_mask:0xf
    v_add_f32_dpp v96, v13, v96 quad_perm:[1,1,1,1] row_mask:0xf bank_mask:0xf
    v_add_f32_dpp v97, v17, v97 quad_perm:[1,1,1,1] row_mask:0xf bank_mask:0xf
    v_add_f32_dpp v98, v21, v98 quad_perm:[1,1,1,1] row_mask:0xf bank_mask:0xf
    v_add_f32_dpp v99, v25, v99 quad_perm:[1,1,1,1] row_mask:0xf bank_mask:0xf
    v_add_f32_dpp v100, v29, v100 quad_perm:[1,1,1,1] row_mask:0xf bank_mask:0xf
    v_add_f32_dpp v101, v33, v101 quad_perm:[1,1,1,1] row_mask:0xf bank_mask:0xf
    v_add_f32_dpp v102, v37, v102 quad_perm:[1,1,1,1] row_mask:0xf bank_mask:0xf
    v_add_f32_dpp v103, v41, v103 quad_perm:[1,1,1,1] row_mask:0xf bank_mask:0xf
    v_add_f32_dpp v96, v14, v96 quad_perm:[2,2,2,2] row_mask:0xf bank_mask:0xf
    v_add_f32_dpp v97, v18, v97 quad_perm:[2,2,2,2] row_mask:0xf bank_mask:0xf
    v_add_f32_dpp v98, v22, v98 quad_perm:[2,2,2,2] row_mask:0xf bank_mask:0xf
    v_add_f32_dpp v99, v26, v99 quad_perm:[2,2,2,2] row_mask:0xf bank_mask:0xf
    v_add_f32_dpp v100, v30, v100 quad_perm:[2,2,2,2] row_mask:0xf bank_mask:0xf
    v_add_f32_dpp v101, v34, v101 quad_perm:[2,2,2,2] row_mask:0xf bank_mask:0xf
    v_add_f32_dpp v102, v38, v102 quad_perm:[2,2,2,2] row_mask:0xf bank_mask:0xf
    v_add_f32_dpp v103, v42, v103 quad_perm:[2,2,2,2] row_mask:0xf bank_mask:0xf
    v_add_f32_dpp v96, v15, v96 quad_perm:[3,3,3,3] row_mask:0xf bank_mask:0xf
    v_add_f32_dpp v97, v19, v97 quad_perm:[3,3,3,3] row_mask:0xf bank_mask:0xf
    v_add_f32_dpp v98, v23, v98 quad_perm:[3,3,3,3] row_mask:0xf bank_mask:0xf
    v_add_f32_dpp v99, v27, v99 quad_perm:[3,3,3,3] row_mask:0xf bank_mask:0xf
    v_add_f32_dpp v100, v31, v100 quad_perm:[3,3,3,3] row_mask:0xf bank_mask:0xf
    v_add_f32_dpp v101, v35, v101 quad_perm:[3,3,3,3] row_mask:0xf bank_mask:0xf
    v_add_f32_dpp v102, v39, v102 quad_perm:[3,3,3,3] row_mask:0xf bank_mask:0xf
    v_add_f32_dpp v103, v43, v103 quad_perm:[3,3,3,3] row_mask:0xf bank_mask:0xf
    v_cvt_pk_bf16_f32 v106, v96, v97
    v_cvt_pk_bf16_f32 v107, v98, v99
    v_cvt_pk_bf16_f32 v108, v100, v101
    v_cvt_pk_bf16_f32 v109, v102, v103
    v_lshlrev_b32 v96, 16, v106
    v_and_b32 v97, s68, v106
    v_lshlrev_b32 v98, 16, v107
    v_and_b32 v99, s68, v107
    v_lshlrev_b32 v100, 16, v108
    v_and_b32 v101, s68, v108
    v_lshlrev_b32 v102, 16, v109
    v_and_b32 v103, s68, v109
    v_mul_f32 v96, s66, v96
    v_mul_f32 v97, s66, v97
    v_mul_f32 v98, s66, v98
    v_mul_f32 v99, s66, v99
    v_mul_f32 v100, s66, v100
    v_mul_f32 v101, s66, v101
    v_mul_f32 v102, s66, v102
    v_mul_f32 v103, s66, v103
    v_cvt_pk_bf16_f32 v106, v96, v97
    v_cvt_pk_bf16_f32 v107, v98, v99
    v_cvt_pk_bf16_f32 v108, v100, v101
    v_cvt_pk_bf16_f32 v109, v102, v103
    v_lshlrev_b32 v96, 16, v106
    v_and_b32 v97, s68, v106
    v_lshlrev_b32 v98, 16, v107
    v_and_b32 v99, s68, v107
    v_lshlrev_b32 v100, 16, v108
    v_and_b32 v101, s68, v108
    v_lshlrev_b32 v102, 16, v109
    v_and_b32 v103, s68, v109
    v_max3_f32 v10, v96, v97, v98
    v_max3_f32 v10, v10, v99, v100
    v_max3_f32 v10, v10, v101, v102
    v_max_f32 v10, v10, v103
    v_mov_b32 v14, 0
    v_mov_b32 v15, 0
    v_mov_b32 v11, v10
    s_nop 1
    v_permlane16_swap_b32 v10, v11
    v_max_f32 v10, v10, v11
    v_mov_b32 v11, v10
    s_nop 1
    v_permlane32_swap_b32 v10, v11
    v_max_f32 v10, v10, v11
    v_mul_f32 v13, s69, v10
    v_fma_f32 v96, v96, s65, v13
    v_fma_f32 v97, v97, s65, v13
    v_fma_f32 v98, v98, s65, v13
    v_fma_f32 v99, v99, s65, v13
    v_fma_f32 v100, v100, s65, v13
    v_fma_f32 v101, v101, s65, v13
    v_fma_f32 v102, v102, s65, v13
    v_fma_f32 v103, v103, s65, v13
    v_exp_f32 v96, v96
    v_mov_b32 v18, 0
    v_mov_b32 v19, 0
    v_exp_f32 v97, v97
    v_mov_b32 v22, 0
    v_mov_b32 v23, 0
    v_exp_f32 v98, v98
    v_mov_b32 v26, 0
    v_mov_b32 v27, 0
    v_exp_f32 v99, v99
    v_mov_b32 v30, 0
    v_mov_b32 v31, 0
    v_exp_f32 v100, v100
    v_mov_b32 v34, 0
    v_mov_b32 v35, 0
    v_exp_f32 v101, v101
    v_mov_b32 v38, 0
    v_mov_b32 v39, 0
    v_exp_f32 v102, v102
    v_mov_b32 v42, 0
    v_mov_b32 v43, 0
    v_exp_f32 v103, v103
    v_mov_b32 v46, 0
    v_mov_b32 v47, 0
    v_cvt_pk_bf16_f32 v106, v96, v96
    v_cvt_pk_bf16_f32 v107, v97, v97
    v_cvt_pk_bf16_f32 v108, v98, v98
    v_cvt_pk_bf16_f32 v109, v99, v99
    v_cvt_pk_bf16_f32 v110, v100, v100
    v_cvt_pk_bf16_f32 v111, v101, v101
    v_cvt_pk_bf16_f32 v112, v102, v102
    v_cvt_pk_bf16_f32 v113, v103, v103
    v_add_f32 v96, v96, v97
    v_add_f32 v98, v98, v99
    v_add_f32 v100, v100, v101
    v_add_f32 v102, v102, v103
    v_add_f32 v96, v96, v98
    v_add_f32 v100, v100, v102
    v_add_f32 v11, v96, v100
    v_mov_b32 v13, v11
    s_nop 1
    v_permlane16_swap_b32 v11, v13
    v_add_f32 v11, v11, v13
    v_mov_b32 v13, v11
    s_nop 1
    v_permlane32_swap_b32 v11, v13
    v_add_f32 v11, v11, v13
    v_bfe_u32 v13, v1, 2, 2
    v_lshlrev_b32 v13, 7, v13
    s_lshl_b32 s7, s3, 3
    v_add_u32 v13, s7, v13
    v_mov_b32 v125, 1
    s_mov_b64 exec, 0x1111
    ds_write_b64 v13, v[10:11] offset:256
    s_mov_b64 exec, 1
    ds_add_u32 v0, v125 offset:8
    s_mov_b64 exec, -1
    s_cmp_lt_u32 s3, 12
    s_cbranch_scc1 L_vl28
    s_setprio 1
    buffer_load_dwordx4 v[56:59], v3, s[44:47], s13 offen nt
    s_add_u32 s14, s13, 4096
    buffer_load_dwordx4 v[60:63], v3, s[44:47], s14 offen nt
    s_add_u32 s14, s13, 8192
    buffer_load_dwordx4 v[64:67], v3, s[44:47], s14 offen nt
    s_add_u32 s14, s13, 12288
    buffer_load_dwordx4 v[68:71], v3, s[44:47], s14 offen nt
    s_add_u32 s14, s13, 16384
    buffer_load_dwordx4 v[72:75], v3, s[44:47], s14 offen nt
    s_add_u32 s14, s13, 20480
    buffer_load_dwordx4 v[76:79], v3, s[44:47], s14 offen nt
    s_add_u32 s14, s13, 24576
    buffer_load_dwordx4 v[80:83], v3, s[44:47], s14 offen nt
    s_add_u32 s14, s13, 28672
    buffer_load_dwordx4 v[84:87], v3, s[44:47], s14 offen nt
L_vl28:
    v_and_b32 v16, v8, v106
    v_and_b32 v17, v9, v106
    v_and_b32 v20, v8, v107
    v_and_b32 v21, v9, v107
    v_and_b32 v24, v8, v108
    v_and_b32 v25, v9, v108
    v_and_b32 v28, v8, v109
    v_and_b32 v29, v9, v109
    v_and_b32 v32, v8, v110
    v_and_b32 v33, v9, v110
    v_and_b32 v36, v8, v111
    v_and_b32 v37, v9, v111
    v_and_b32 v40, v8, v112
    v_and_b32 v41, v9, v112
    v_and_b32 v44, v8, v113
    v_and_b32 v45, v9, v113
    s_lshl_b32 s7, s3, 11
    s_add_u32 s7, s7, 81920
    v_add_u32 v13, s7, v2
    s_cmp_ge_u32 s3, 12
    s_cselect_b32 s7, 20, 16
    v_mov_b32 v124, s7
    s_lshr_b32 s7, s3, 2
    s_cmp_eq_u32 s7, 2
    s_cselect_b32 s7, 0x100, 1
    v_mov_b32 v125, s7
    s_waitcnt vmcnt(7)
    v_mfma_f32_16x16x32_bf16 v[116:119], v[16:19], v[56:59], 0
    v_mfma_f32_16x16x32_bf16 v[120:123], v[14:17], v[56:59], 0
    s_waitcnt vmcnt(6)
    v_mfma_f32_16x16x32_bf16 v[116:119], v[20:23], v[60:63], v[116:119]
    v_mfma_f32_16x16x32_bf16 v[120:123], v[18:21], v[60:63], v[120:123]
    s_waitcnt vmcnt(5)
    v_mfma_f32_16x16x32_bf16 v[116:119], v[24:27], v[64:67], v[116:119]
    v_mfma_f32_16x16x32_bf16 v[120:123], v[22:25], v[64:67], v[120:123]
    s_waitcnt vmcnt(4)
    v_mfma_f32_16x16x32_bf16 v[116:119], v[28:31], v[68:71], v[116:119]
    v_mfma_f32_16x16x32_bf16 v[120:123], v[26:29], v[68:71], v[120:123]
    s_waitcnt vmcnt(3)
    v_mfma_f32_16x16x32_bf16 v[116:119], v[32:35], v[72:75], v[116:119]
    v_mfma_f32_16x16x32_bf16 v[120:123], v[30:33], v[72:75], v[120:123]
    s_waitcnt vmcnt(2)
    v_mfma_f32_16x16x32_bf16 v[116:119], v[36:39], v[76:79], v[116:119]
    v_mfma_f32_16x16x32_bf16 v[120:123], v[34:37], v[76:79], v[120:123]
    s_waitcnt vmcnt(1)
    v_mfma_f32_16x16x32_bf16 v[116:119], v[40:43], v[80:83], v[116:119]
    v_mfma_f32_16x16x32_bf16 v[120:123], v[38:41], v[80:83], v[120:123]
    s_waitcnt vmcnt(0)
    v_mfma_f32_16x16x32_bf16 v[116:119], v[44:47], v[84:87], v[116:119]
    v_mfma_f32_16x16x32_bf16 v[120:123], v[42:45], v[84:87], v[120:123]
    s_nop 6
    ds_write_b128 v13, v[116:119]
    ds_write_b128 v13, v[120:123] offset:16
    s_mov_b64 exec, 1
    ds_add_u32 v124, v125
    s_branch L_b2
L_att9:
    s_cmp_ge_u32 s3, 12
    s_cbranch_scc1 L_vskip9
    s_cmp_lt_u32 s3, 4
    s_cbranch_scc1 L_vq9
    s_setprio 1
    buffer_load_dwordx4 v[56:59], v3, s[44:47], s13 offen nt
    s_add_u32 s14, s13, 4096
    buffer_load_dwordx4 v[60:63], v3, s[44:47], s14 offen nt
    s_add_u32 s14, s13, 8192
    buffer_load_dwordx4 v[64:67], v3, s[44:47], s14 offen nt
    s_add_u32 s14, s13, 12288
    buffer_load_dwordx4 v[68:71], v3, s[44:47], s14 offen nt
    s_add_u32 s14, s13, 16384
    buffer_load_dwordx4 v[72:75], v3, s[44:47], s14 offen nt
    s_add_u32 s14, s13, 20480
    buffer_load_dwordx4 v[76:79], v3, s[44:47], s14 offen nt
    s_add_u32 s14, s13, 24576
    buffer_load_dwordx4 v[80:83], v3, s[44:47], s14 offen nt
    s_add_u32 s14, s13, 28672
    buffer_load_dwordx4 v[84:87], v3, s[44:47], s14 offen nt
    s_add_u32 s14, s13, 32768
    buffer_load_dwordx4 v[88:91], v3, s[44:47], s14 offen nt
    s_branch L_vtag9
L_vq9:
    s_setprio 3
    s_mov_b32 s70, 0
L_lw9:
    ds_read_b32 v10, v0 offset:4
    s_add_u32 s70, s70, 1
    s_waitcnt lgkmcnt(0)
    v_readfirstlane_b32 s7, v10
    s_nop 0
    s_cmp_eq_u32 s7, 1
    s_cbranch_scc1 L_lwd9
    s_sleep 1
    s_cmp_lt_u32 s70, 262144
    s_cbranch_scc1 L_lw9
L_lwd9:
    s_call_b64 s[76:77], L_qissue
    s_branch L_vdone9
L_vskip9:
    s_waitcnt vmcnt(0)
L_vtag9:
    s_waitcnt lgkmcnt(0)
    s_mov_b32 s64, s6
L_tagok9:
    s_mul_i32 s64, s64, 0x9E3779B1
    s_add_u32 s64, s64, 0x7F4A7C15
    s_and_b32 s8, s64, 0xff
    s_bfe_u32 s9, s64, 0x80008
    s_cmp_eq_u32 s8, s9
    s_cbranch_scc1 L_tagok9
    s_bfe_u32 s10, s64, 0x80010
    s_lshr_b32 s11, s64, 24
L_vdone9:
    s_mov_b32 s75, s3
    v_and_b32 v10, 1, v1
    v_lshlrev_b32 v10, 4, v10
    v_mov_b32 v11, 0xffff
    v_lshlrev_b32 v11, v10, v11
    v_and_b32 v10, 2, v1
    v_cmp_eq_u32 vcc, 0, v10
    s_nop 1
    v_cndmask_b32 v8, 0, v11, vcc
    v_cndmask_b32 v9, v11, 0, vcc
    v_lshlrev_b32 v2, 5, v1
    s_mov_b32 s70, 0
L_lw10:
    ds_read_b32 v10, v0 offset:0
    s_add_u32 s70, s70, 1
    s_waitcnt lgkmcnt(0)
    v_readfirstlane_b32 s71, v10
    s_nop 0
    s_and_b32 s7, s71, 0xff
    s_cmp_eq_u32 s7, 4
    s_cbranch_scc1 L_lwd10
    s_sleep 4
    s_cmp_lt_u32 s70, 262144
    s_cbranch_scc1 L_lw10
L_lwd10:
    s_setprio 2
    ds_read_b128 v[96:99], v2 offset:8192
    ds_read_b128 v[100:103], v2 offset:8208
    ds_read_b128 v[104:107], v2 offset:10240
    ds_read_b128 v[108:111], v2 offset:10256
    ds_read_b128 v[112:115], v2 offset:12288
    ds_read_b128 v[116:119], v2 offset:12304
    ds_read_b128 v[120:123], v2 offset:14336
    ds_read_b128 v[124:127], v2 offset:14352
    s_waitcnt lgkmcnt(0)
    v_pk_add_f32 v[96:97], v[96:97], v[104:105]
    v_pk_add_f32 v[112:113], v[112:113], v[120:121]
    v_pk_add_f32 v[98:99], v[98:99], v[106:107]
    v_pk_add_f32 v[114:115], v[114:115], v[122:123]
    v_pk_add_f32 v[100:101], v[100:101], v[108:109]
    v_pk_add_f32 v[116:117], v[116:117], v[124:125]
    v_pk_add_f32 v[102:103], v[102:103], v[110:111]
    v_pk_add_f32 v[118:119], v[118:119], v[126:127]
    v_pk_add_f32 v[96:97], v[96:97], v[112:113]
    v_pk_add_f32 v[98:99], v[98:99], v[114:115]
    v_pk_add_f32 v[100:101], v[100:101], v[116:117]
    v_pk_add_f32 v[102:103], v[102:103], v[118:119]
    v_cvt_pk_bf16_f32 v4, v96, v97
    v_cvt_pk_bf16_f32 v5, v98, v99
    v_cvt_pk_bf16_f32 v6, v100, v101
    v_cvt_pk_bf16_f32 v7, v102, v103
    s_waitcnt vmcnt(17)
    s_nop 0
    v_mfma_f32_16x16x32_bf16 v[12:15], v[16:19], v[4:7], 0
    s_waitcnt vmcnt(16)
    v_mfma_f32_16x16x32_bf16 v[16:19], v[20:23], v[4:7], 0
    s_waitcnt vmcnt(15)
    v_mfma_f32_16x16x32_bf16 v[20:23], v[24:27], v[4:7], 0
    s_waitcnt vmcnt(14)
    v_mfma_f32_16x16x32_bf16 v[24:27], v[28:31], v[4:7], 0
    s_waitcnt vmcnt(13)
    v_mfma_f32_16x16x32_bf16 v[28:31], v[32:35], v[4:7], 0
    s_waitcnt vmcnt(12)
    v_mfma_f32_16x16x32_bf16 v[32:35], v[36:39], v[4:7], 0
    s_waitcnt vmcnt(11)
    v_mfma_f32_16x16x32_bf16 v[36:39], v[40:43], v[4:7], 0
    s_waitcnt vmcnt(10)
    v_mfma_f32_16x16x32_bf16 v[40:43], v[44:47], v[4:7], 0
    s_waitcnt vmcnt(9)
    v_mfma_f32_16x16x32_bf16 v[44:47], v[48:51], v[4:7], 0
    v_mov_b32_dpp v96, v12 quad_perm:[0,0,0,0] row_mask:0xf bank_mask:0xf
    v_mov_b32_dpp v97, v16 quad_perm:[0,0,0,0] row_mask:0xf bank_mask:0xf
    v_mov_b32_dpp v98, v20 quad_perm:[0,0,0,0] row_mask:0xf bank_mask:0xf
    v_mov_b32_dpp v99, v24 quad_perm:[0,0,0,0] row_mask:0xf bank_mask:0xf
    v_mov_b32_dpp v100, v28 quad_perm:[0,0,0,0] row_mask:0xf bank_mask:0xf
    v_mov_b32_dpp v101, v32 quad_perm:[0,0,0,0] row_mask:0xf bank_mask:0xf
    v_mov_b32_dpp v102, v36 quad_perm:[0,0,0,0] row_mask:0xf bank_mask:0xf
    v_mov_b32_dpp v103, v40 quad_perm:[0,0,0,0] row_mask:0xf bank_mask:0xf
    v_mov_b32_dpp v104, v44 quad_perm:[0,0,0,0] row_mask:0xf bank_mask:0xf
    v_add_f32_dpp v96, v13, v96 quad_perm:[1,1,1,1] row_mask:0xf bank_mask:0xf
    v_add_f32_dpp v97, v17, v97 quad_perm:[1,1,1,1] row_mask:0xf bank_mask:0xf
    v_add_f32_dpp v98, v21, v98 quad_perm:[1,1,1,1] row_mask:0xf bank_mask:0xf
    v_add_f32_dpp v99, v25, v99 quad_perm:[1,1,1,1] row_mask:0xf bank_mask:0xf
    v_add_f32_dpp v100, v29, v100 quad_perm:[1,1,1,1] row_mask:0xf bank_mask:0xf
    v_add_f32_dpp v101, v33, v101 quad_perm:[1,1,1,1] row_mask:0xf bank_mask:0xf
    v_add_f32_dpp v102, v37, v102 quad_perm:[1,1,1,1] row_mask:0xf bank_mask:0xf
    v_add_f32_dpp v103, v41, v103 quad_perm:[1,1,1,1] row_mask:0xf bank_mask:0xf
    v_add_f32_dpp v104, v45, v104 quad_perm:[1,1,1,1] row_mask:0xf bank_mask:0xf
    v_add_f32_dpp v96, v14, v96 quad_perm:[2,2,2,2] row_mask:0xf bank_mask:0xf
    v_add_f32_dpp v97, v18, v97 quad_perm:[2,2,2,2] row_mask:0xf bank_mask:0xf
    v_add_f32_dpp v98, v22, v98 quad_perm:[2,2,2,2] row_mask:0xf bank_mask:0xf
    v_add_f32_dpp v99, v26, v99 quad_perm:[2,2,2,2] row_mask:0xf bank_mask:0xf
    v_add_f32_dpp v100, v30, v100 quad_perm:[2,2,2,2] row_mask:0xf bank_mask:0xf
    v_add_f32_dpp v101, v34, v101 quad_perm:[2,2,2,2] row_mask:0xf bank_mask:0xf
    v_add_f32_dpp v102, v38, v102 quad_perm:[2,2,2,2] row_mask:0xf bank_mask:0xf
    v_add_f32_dpp v103, v42, v103 quad_perm:[2,2,2,2] row_mask:0xf bank_mask:0xf
    v_add_f32_dpp v104, v46, v104 quad_perm:[2,2,2,2] row_mask:0xf bank_mask:0xf
    v_add_f32_dpp v96, v15, v96 quad_perm:[3,3,3,3] row_mask:0xf bank_mask:0xf
    v_add_f32_dpp v97, v19, v97 quad_perm:[3,3,3,3] row_mask:0xf bank_mask:0xf
    v_add_f32_dpp v98, v23, v98 quad_perm:[3,3,3,3] row_mask:0xf bank_mask:0xf
    v_add_f32_dpp v99, v27, v99 quad_perm:[3,3,3,3] row_mask:0xf bank_mask:0xf
    v_add_f32_dpp v100, v31, v100 quad_perm:[3,3,3,3] row_mask:0xf bank_mask:0xf
    v_add_f32_dpp v101, v35, v101 quad_perm:[3,3,3,3] row_mask:0xf bank_mask:0xf
    v_add_f32_dpp v102, v39, v102 quad_perm:[3,3,3,3] row_mask:0xf bank_mask:0xf
    v_add_f32_dpp v103, v43, v103 quad_perm:[3,3,3,3] row_mask:0xf bank_mask:0xf
    v_add_f32_dpp v104, v47, v104 quad_perm:[3,3,3,3] row_mask:0xf bank_mask:0xf
    v_cvt_pk_bf16_f32 v106, v96, v97
    v_cvt_pk_bf16_f32 v107, v98, v99
    v_cvt_pk_bf16_f32 v108, v100, v101
    v_cvt_pk_bf16_f32 v109, v102, v103
    v_cvt_pk_bf16_f32 v110, v104, v104
    v_lshlrev_b32 v96, 16, v106
    v_and_b32 v97, s68, v106
    v_lshlrev_b32 v98, 16, v107
    v_and_b32 v99, s68, v107
    v_lshlrev_b32 v100, 16, v108
    v_and_b32 v101, s68, v108
    v_lshlrev_b32 v102, 16, v109
    v_and_b32 v103, s68, v109
    v_lshlrev_b32 v104, 16, v110
    v_mul_f32 v96, s66, v96
    v_mul_f32 v97, s66, v97
    v_mul_f32 v98, s66, v98
    v_mul_f32 v99, s66, v99
    v_mul_f32 v100, s66, v100
    v_mul_f32 v101, s66, v101
    v_mul_f32 v102, s66, v102
    v_mul_f32 v103, s66, v103
    v_mul_f32 v104, s66, v104
    v_cvt_pk_bf16_f32 v106, v96, v97
    v_cvt_pk_bf16_f32 v107, v98, v99
    v_cvt_pk_bf16_f32 v108, v100, v101
    v_cvt_pk_bf16_f32 v109, v102, v103
    v_cvt_pk_bf16_f32 v110, v104, v104
    v_lshlrev_b32 v96, 16, v106
    v_and_b32 v97, s68, v106
    v_lshlrev_b32 v98, 16, v107
    v_and_b32 v99, s68, v107
    v_lshlrev_b32 v100, 16, v108
    v_and_b32 v101, s68, v108
    v_lshlrev_b32 v102, 16, v109
    v_and_b32 v103, s68, v109
    v_lshlrev_b32 v104, 16, v110
    v_max3_f32 v10, v96, v97, v98
    v_max3_f32 v10, v10, v99, v100
    v_max3_f32 v10, v10, v101, v102
    v_max3_f32 v10, v10, v103, v104
    v_mov_b32 v14, 0
    v_mov_b32 v15, 0
    v_mov_b32 v11, v10
    s_nop 1
    v_permlane16_swap_b32 v10, v11
    v_max_f32 v10, v10, v11
    v_mov_b32 v11, v10
    s_nop 1
    v_permlane32_swap_b32 v10, v11
    v_max_f32 v10, v10, v11
    v_mul_f32 v13, s69, v10
    v_fma_f32 v96, v96, s65, v13
    v_fma_f32 v97, v97, s65, v13
    v_fma_f32 v98, v98, s65, v13
    v_fma_f32 v99, v99, s65, v13
    v_fma_f32 v100, v100, s65, v13
    v_fma_f32 v101, v101, s65, v13
    v_fma_f32 v102, v102, s65, v13
    v_fma_f32 v103, v103, s65, v13
    v_fma_f32 v104, v104, s65, v13
    v_exp_f32 v96, v96
    v_mov_b32 v18, 0
    v_mov_b32 v19, 0
    v_exp_f32 v97, v97
    v_mov_b32 v22, 0
    v_mov_b32 v23, 0
    v_exp_f32 v98, v98
    v_mov_b32 v26, 0
    v_mov_b32 v27, 0
    v_exp_f32 v99, v99
    v_mov_b32 v30, 0
    v_mov_b32 v31, 0
    v_exp_f32 v100, v100
    v_mov_b32 v34, 0
    v_mov_b32 v35, 0
    v_exp_f32 v101, v101
    v_mov_b32 v38, 0
    v_mov_b32 v39, 0
    v_exp_f32 v102, v102
    v_mov_b32 v42, 0
    v_mov_b32 v43, 0
    v_exp_f32 v103, v103
    v_mov_b32 v46, 0
    v_mov_b32 v47, 0
    v_exp_f32 v104, v104
    v_mov_b32 v50, 0
    v_mov_b32 v51, 0
    v_cvt_pk_bf16_f32 v106, v96, v96
    v_cvt_pk_bf16_f32 v107, v97, v97
    v_cvt_pk_bf16_f32 v108, v98, v98
    v_cvt_pk_bf16_f32 v109, v99, v99
    v_cvt_pk_bf16_f32 v110, v100, v100
    v_cvt_pk_bf16_f32 v111, v101, v101
    v_cvt_pk_bf16_f32 v112, v102, v102
    v_cvt_pk_bf16_f32 v113, v103, v103
    v_cvt_pk_bf16_f32 v114, v104, v104
    v_add_f32 v96, v96, v97
    v_add_f32 v98, v98, v99
    v_add_f32 v100, v100, v101
    v_add_f32 v102, v102, v103
    v_add_f32 v96, v96, v98
    v_add_f32 v100, v100, v102
    v_add_f32 v96, v96, v100
    v_add_f32 v11, v96, v104
    v_mov_b32 v13, v11
    s_nop 1
    v_permlane16_swap_b32 v11, v13
    v_add_f32 v11, v11, v13
    v_mov_b32 v13, v11
    s_nop 1
    v_permlane32_swap_b32 v11, v13
    v_add_f32 v11, v11, v13
    v_bfe_u32 v13, v1, 2, 2
    v_lshlrev_b32 v13, 7, v13
    s_lshl_b32 s7, s3, 3
    v_add_u32 v13, s7, v13
    v_mov_b32 v125, 1
    s_mov_b64 exec, 0x1111
    ds_write_b64 v13, v[10:11] offset:256
    s_mov_b64 exec, 1
    ds_add_u32 v0, v125 offset:8
    s_mov_b64 exec, -1
    s_cmp_lt_u32 s3, 12
    s_cbranch_scc1 L_vl29
    s_setprio 1
    buffer_load_dwordx4 v[56:59], v3, s[44:47], s13 offen nt
    s_add_u32 s14, s13, 4096
    buffer_load_dwordx4 v[60:63], v3, s[44:47], s14 offen nt
    s_add_u32 s14, s13, 8192
    buffer_load_dwordx4 v[64:67], v3, s[44:47], s14 offen nt
    s_add_u32 s14, s13, 12288
    buffer_load_dwordx4 v[68:71], v3, s[44:47], s14 offen nt
    s_add_u32 s14, s13, 16384
    buffer_load_dwordx4 v[72:75], v3, s[44:47], s14 offen nt
    s_add_u32 s14, s13, 20480
    buffer_load_dwordx4 v[76:79], v3, s[44:47], s14 offen nt
    s_add_u32 s14, s13, 24576
    buffer_load_dwordx4 v[80:83], v3, s[44:47], s14 offen nt
    s_add_u32 s14, s13, 28672
    buffer_load_dwordx4 v[84:87], v3, s[44:47], s14 offen nt
    s_add_u32 s14, s13, 32768
    buffer_load_dwordx4 v[88:91], v3, s[44:47], s14 offen nt
L_vl29:
    v_and_b32 v16, v8, v106
    v_and_b32 v17, v9, v106
    v_and_b32 v20, v8, v107
    v_and_b32 v21, v9, v107
    v_and_b32 v24, v8, v108
    v_and_b32 v25, v9, v108
    v_and_b32 v28, v8, v109
    v_and_b32 v29, v9, v109
    v_and_b32 v32, v8, v110
    v_and_b32 v33, v9, v110
    v_and_b32 v36, v8, v111
    v_and_b32 v37, v9, v111
    v_and_b32 v40, v8, v112
    v_and_b32 v41, v9, v112
    v_and_b32 v44, v8, v113
    v_and_b32 v45, v9, v113
    v_and_b32 v48, v8, v114
    v_and_b32 v49, v9, v114
    s_lshl_b32 s7, s3, 11
    s_add_u32 s7, s7, 81920
    v_add_u32 v13, s7, v2
    s_cmp_ge_u32 s3, 12
    s_cselect_b32 s7, 20, 16
    v_mov_b32 v124, s7
    s_lshr_b32 s7, s3, 2
    s_cmp_eq_u32 s7, 2
    s_cselect_b32 s7, 0x100, 1
    v_mov_b32 v125, s7
    s_waitcnt vmcnt(8)
    v_mfma_f32_16x16x32_bf16 v[116:119], v[16:19], v[56:59], 0
    v_mfma_f32_16x16x32_bf16 v[120:123], v[14:17], v[56:59], 0
    s_waitcnt vmcnt(7)
    v_mfma_f32_16x16x32_bf16 v[116:119], v[20:23], v[60:63], v[116:119]
    v_mfma_f32_16x16x32_bf16 v[120:123], v[18:21], v[60:63], v[120:123]
    s_waitcnt vmcnt(6)
    v_mfma_f32_16x16x32_bf16 v[116:119], v[24:27], v[64:67], v[116:119]
    v_mfma_f32_16x16x32_bf16 v[120:123], v[22:25], v[64:67], v[120:123]
    s_waitcnt vmcnt(5)
    v_mfma_f32_16x16x32_bf16 v[116:119], v[28:31], v[68:71], v[116:119]
    v_mfma_f32_16x16x32_bf16 v[120:123], v[26:29], v[68:71], v[120:123]
    s_waitcnt vmcnt(4)
    v_mfma_f32_16x16x32_bf16 v[116:119], v[32:35], v[72:75], v[116:119]
    v_mfma_f32_16x16x32_bf16 v[120:123], v[30:33], v[72:75], v[120:123]
    s_waitcnt vmcnt(3)
    v_mfma_f32_16x16x32_bf16 v[116:119], v[36:39], v[76:79], v[116:119]
    v_mfma_f32_16x16x32_bf16 v[120:123], v[34:37], v[76:79], v[120:123]
    s_waitcnt vmcnt(2)
    v_mfma_f32_16x16x32_bf16 v[116:119], v[40:43], v[80:83], v[116:119]
    v_mfma_f32_16x16x32_bf16 v[120:123], v[38:41], v[80:83], v[120:123]
    s_waitcnt vmcnt(1)
    v_mfma_f32_16x16x32_bf16 v[116:119], v[44:47], v[84:87], v[116:119]
    v_mfma_f32_16x16x32_bf16 v[120:123], v[42:45], v[84:87], v[120:123]
    s_waitcnt vmcnt(0)
    v_mfma_f32_16x16x32_bf16 v[116:119], v[48:51], v[88:91], v[116:119]
    v_mfma_f32_16x16x32_bf16 v[120:123], v[46:49], v[88:91], v[120:123]
    s_nop 6
    ds_write_b128 v13, v[116:119]
    ds_write_b128 v13, v[120:123] offset:16
    s_mov_b64 exec, 1
    ds_add_u32 v124, v125
L_b2:
    s_mov_b64 exec, -1
    s_cmp_ge_u32 s3, 12
    s_cbranch_scc1 L_gemvw
    s_sub_u32 s7, s3, 4
    s_cmp_lt_u32 s7, 4
    s_cbranch_scc1 L_roles
    s_and_b32 s74, s3, 3
    v_and_b32 v12, 15, v1
    v_lshlrev_b32 v12, 3, v12
    s_lshl_b32 s7, s74, 7
    v_add_u32 v12, s7, v12
    v_lshlrev_b32 v4, 3, v1
    s_lshl_b32 s7, s74, 9
    v_add_u32 v4, s7, v4
    v_add_u32 v5, 81920, v4
    v_and_b32 v6, 1, v1
    v_lshlrev_b32 v6, 4, v6
    v_lshrrev_b32 v7, v6, s64
    v_and_b32 v6, 0xff, v7
    v_bfe_u32 v7, v7, 8, 8
    s_lshl_b32 s15, s4, 5
    s_add_u32 s15, s15, s5
    s_lshl_b32 s16, s15, 11
    s_add_u32 s16, s16, 131072
    s_mov_b32 s70, 0
L_lw11:
    ds_read_b32 v10, v0 offset:8
    s_add_u32 s70, s70, 1
    s_waitcnt lgkmcnt(0)
    v_readfirstlane_b32 s7, v10
    s_nop 0
    s_cmp_eq_u32 s7, 16
    s_cbranch_scc1 L_lwd11
    s_sleep 1
    s_cmp_lt_u32 s70, 262144
    s_cbranch_scc1 L_lw11
L_lwd11:
    ds_read_b64 v[10:11], v12 offset:256
    s_waitcnt lgkmcnt(0)
    v_max_f32_dpp v15, v10, v10 row_ror:1 row_mask:0xf bank_mask:0xf
    s_nop 1
    v_max_f32_dpp v15, v15, v15 row_ror:2 row_mask:0xf bank_mask:0xf
    s_nop 1
    v_max_f32_dpp v15, v15, v15 row_ror:4 row_mask:0xf bank_mask:0xf
    s_nop 1
    v_max_f32_dpp v15, v15, v15 row_ror:8 row_mask:0xf bank_mask:0xf
    v_sub_f32 v14, v10, v15
    v_mul_f32 v14, s65, v14
    v_exp_f32 v14, v14
    s_cmp_ge_u32 s3, 8
    s_cbranch_scc1 L_comb
    v_mul_f32 v11, v14, v11
    v_and_b32 v8, 3, v1
    v_lshlrev_b32 v9, 3, v8
    v_lshrrev_b32 v9, v9, s64
    v_and_b32 v9, 0xff, v9
    v_lshlrev_b32 v8, 2, v8
    s_lshl_b32 s17, s15, 7
    s_lshl_b32 s7, s74, 4
    s_add_u32 s17, s17, s7
    s_add_u32 s17, s17, 32768
    v_add_f32_dpp v11, v11, v11 row_ror:1 row_mask:0xf bank_mask:0xf
    s_nop 1
    v_add_f32_dpp v11, v11, v11 row_ror:2 row_mask:0xf bank_mask:0xf
    s_nop 1
    v_add_f32_dpp v11, v11, v11 row_ror:4 row_mask:0xf bank_mask:0xf
    s_nop 1
    v_add_f32_dpp v11, v11, v11 row_ror:8 row_mask:0xf bank_mask:0xf
    v_cmp_eq_u32 vcc, 0, v1
    s_nop 1
    v_cndmask_b32 v11, v11, v15, vcc
    v_and_or_b32 v11, v11, s67, v9
    s_mov_b64 exec, 0xf
    s_cmp_eq_u32 s71, 4
    s_cbranch_scc1 L_mst_same
    buffer_store_dword v11, v8, s[48:51], s17 offen sc1
    s_branch L_mst_done
L_mst_same:
    buffer_store_dword v11, v8, s[48:51], s17 offen
L_mst_done:
    s_mov_b64 exec, -1
    s_branch L_roles
L_comb:
    s_nop 1
    v_mov_b32_dpp v48, v14 row_newbcast:12 row_mask:0xf bank_mask:0xf
    v_mov_b32_dpp v49, v14 row_newbcast:13 row_mask:0xf bank_mask:0xf
    v_mov_b32_dpp v50, v14 row_newbcast:14 row_mask:0xf bank_mask:0xf
    v_mov_b32_dpp v51, v14 row_newbcast:15 row_mask:0xf bank_mask:0xf
    s_mov_b32 s70, 0
L_lw12:
    ds_read_b32 v10, v0 offset:16
    s_add_u32 s70, s70, 1
    s_waitcnt lgkmcnt(0)
    v_readfirstlane_b32 s7, v10
    s_nop 0
    s_cmp_eq_u32 s7, 1032
    s_cbranch_scc1 L_lwd12
    s_cmp_lt_u32 s70, 262144
    s_cbranch_scc1 L_lw12
L_lwd12:
    ds_read2st64_b64 v[16:19], v5 offset0:0 offset1:4
    ds_read2st64_b64 v[20:23], v5 offset0:8 offset1:12
    ds_read2st64_b64 v[24:27], v5 offset0:16 offset1:20
    ds_read2st64_b64 v[28:31], v5 offset0:24 offset1:28
    ds_read2st64_b64 v[32:35], v5 offset0:32 offset1:36
    ds_read2st64_b64 v[36:39], v5 offset0:40 offset1:44
    s_waitcnt lgkmcnt(0)
    v_mul_f32_dpp v40, v14, v16 row_newbcast:0 row_mask:0xf bank_mask:0xf
    v_mul_f32_dpp v41, v14, v17 row_newbcast:0 row_mask:0xf bank_mask:0xf
    v_mul_f32_dpp v42, v14, v18 row_newbcast:1 row_mask:0xf bank_mask:0xf
    v_mul_f32_dpp v43, v14, v19 row_newbcast:1 row_mask:0xf bank_mask:0xf
    v_fmac_f32_dpp v40, v14, v20 row_newbcast:2 row_mask:0xf bank_mask:0xf
    v_fmac_f32_dpp v41, v14, v21 row_newbcast:2 row_mask:0xf bank_mask:0xf
    v_fmac_f32_dpp v42, v14, v22 row_newbcast:3 row_mask:0xf bank_mask:0xf
    v_fmac_f32_dpp v43, v14, v23 row_newbcast:3 row_mask:0xf bank_mask:0xf
    v_fmac_f32_dpp v40, v14, v24 row_newbcast:4 row_mask:0xf bank_mask:0xf
    v_fmac_f32_dpp v41, v14, v25 row_newbcast:4 row_mask:0xf bank_mask:0xf
    v_fmac_f32_dpp v42, v14, v26 row_newbcast:5 row_mask:0xf bank_mask:0xf
    v_fmac_f32_dpp v43, v14, v27 row_newbcast:5 row_mask:0xf bank_mask:0xf
    v_fmac_f32_dpp v40, v14, v28 row_newbcast:6 row_mask:0xf bank_mask:0xf
    v_fmac_f32_dpp v41, v14, v29 row_newbcast:6 row_mask:0xf bank_mask:0xf
    v_fmac_f32_dpp v42, v14, v30 row_newbcast:7 row_mask:0xf bank_mask:0xf
    v_fmac_f32_dpp v43, v14, v31 row_newbcast:7 row_mask:0xf bank_mask:0xf
    v_fmac_f32_dpp v40, v14, v32 row_newbcast:8 row_mask:0xf bank_mask:0xf
    v_fmac_f32_dpp v41, v14, v33 row_newbcast:8 row_mask:0xf bank_mask:0xf
    v_fmac_f32_dpp v42, v14, v34 row_newbcast:9 row_mask:0xf bank_mask:0xf
    v_fmac_f32_dpp v43, v14, v35 row_newbcast:9 row_mask:0xf bank_mask:0xf
    v_fmac_f32_dpp v40, v14, v36 row_newbcast:10 row_mask:0xf bank_mask:0xf
    v_fmac_f32_dpp v41, v14, v37 row_newbcast:10 row_mask:0xf bank_mask:0xf
    v_fmac_f32_dpp v42, v14, v38 row_newbcast:11 row_mask:0xf bank_mask:0xf
    v_fmac_f32_dpp v43, v14, v39 row_newbcast:11 row_mask:0xf bank_mask:0xf
    s_mov_b32 s70, 0
L_waitB:
    ds_read_b32 v10, v0 offset:20
    ds_read2st64_b64 v[16:19], v5 offset0:48 offset1:52
    ds_read2st64_b64 v[20:23], v5 offset0:56 offset1:60
    s_add_u32 s70, s70, 1
    s_waitcnt lgkmcnt(2)
    v_readfirstlane_b32 s7, v10
    s_nop 0
    s_cmp_eq_u32 s7, 4
    s_cbranch_scc1 L_gotB
    s_cmp_lt_u32 s70, 262144
    s_cbranch_scc1 L_waitB
L_gotB:
    s_cmp_eq_u32 s71, 4
    s_waitcnt lgkmcnt(0)
    v_pk_fma_f32 v[40:41], v[16:17], v[48:49], v[40:41] op_sel_hi:[1,0,1]
    v_pk_fma_f32 v[42:43], v[18:19], v[48:49], v[42:43] op_sel:[0,1,0]
    v_pk_fma_f32 v[40:41], v[20:21], v[50:51], v[40:41] op_sel_hi:[1,0,1]
    v_pk_fma_f32 v[42:43], v[22:23], v[50:51], v[42:43] op_sel:[0,1,0]
    v_pk_add_f32 v[40:41], v[40:41], v[42:43]
    v_and_or_b32 v40, v40, s67, v6
    v_and_or_b32 v41, v41, s67, v7
    s_cbranch_scc0 L_ost_cross
    buffer_store_dwordx2 v[40:41], v4, s[48:51], s16 offen
    s_branch L_cfin
L_ost_cross:
    buffer_store_dwordx2 v[40:41], v4, s[48:51], s16 offen sc1
L_cfin:
    s_cmp_lt_u32 s73, 4
    s_cbranch_scc1 L_nopost
    s_lshl_b32 s16, s72, 2
    s_add_u32 s16, s16, s73
    s_sub_u32 s16, s16, 4
    s_mov_b32 s55, 0x20000
    s_cmp_lt_u32 s74, 2
    s_cselect_b32 s52, s28, s30
    s_cselect_b32 s53, s29, s31
    s_mov_b32 s54, 1835008
    v_lshrrev_b32 v10, 2, v1
    v_mul_u32_u24 v10, 3584, v10
    v_and_b32 v11, 3, v1
    v_lshl_add_u32 v10, v11, 7, v10
    s_lshl_b32 s15, s16, 1
    s_and_b32 s7, s74, 1
    s_add_u32 s15, s15, s7
    s_mul_i32 s15, s15, 57344
    s_mul_i32 s7, s4, 448
    s_and_b32 s7, s7, 0xffffff80
    s_add_u32 s15, s15, s7
    buffer_load_dword v126, v10, s[52:55], s15 offen
L_postdn:
    s_mov_b32 s52, s32
    s_mov_b32 s53, s33
    s_mov_b32 s54, 1835008
    v_lshlrev_b32 v10, 7, v1
    s_lshl_b32 s15, s4, 4
    s_add_u32 s15, s15, s16
    s_lshl_b32 s15, s15, 2
    s_add_u32 s15, s15, s74
    s_mul_i32 s15, s15, 3584
    s_mov_b32 exec_lo, 0x0fffffff
    s_mov_b32 exec_hi, 0
    buffer_load_dword v127, v10, s[52:55], s15 offen
L_nopost:
    s_branch L_fin
L_roles:
    s_setprio 1
    s_lshr_b32 s7, s75, 1
    s_mul_i32 s7, s7, 1088
    s_and_b32 s15, s75, 1
    s_lshl_b32 s15, s15, 9
    s_add_u32 s7, s7, s15
    s_add_u32 s7, s7, 3072
    v_lshl_add_u32 v12, v1, 3, s7
    s_lshl_b32 s78, s4, 13
    s_lshl_b32 s7, s75, 10
    s_add_u32 s78, s78, s7
    s_add_u32 s78, s78, 1703936
    s_cmp_ge_u32 s73, 2
    s_cbranch_scc1 L_noA
    v_lshrrev_b32 v11, 3, v1
    v_and_b32 v13, 7, v1
    v_lshlrev_b32 v6, 4, v13
    v_lshl_add_u32 v2, v11, 11, v6
    v_lshlrev_b32 v4, 7, v11
    v_lshrrev_b32 v10, 5, v1
    v_lshl_add_u32 v6, v10, 3, v6
    s_lshl_b32 s74, s73, 3
    s_add_u32 s74, s74, s3
    s_lshl_b32 s7, s4, 5
    s_lshl_b32 s15, s72, 3
    s_add_u32 s7, s7, s15
    s_lshl_b32 s77, s7, 11
    s_lshl_b32 s15, s74, 7
    s_add_u32 s77, s77, s15
    s_add_u32 s77, s77, 131072
    s_lshl_b32 s16, s7, 7
    s_lshr_b32 s7, s74, 2
    s_lshl_b32 s7, s7, 4
    s_add_u32 s16, s16, s7
    s_add_u32 s16, s16, 32768
    s_lshl_b32 s17, s4, 13
    s_lshl_b32 s7, s72, 11
    s_add_u32 s17, s17, s7
    s_add_u32 s17, s17, s15
    s_add_u32 s17, s17, 1703936
    v_mov_b32 v25, s64
    v_mov_b32 v27, s64
    s_mov_b64 s[18:19], 0
    s_mov_b64 exec, 0
    s_mov_b32 s36, 1
    s_mov_b32 s70, 0
    s_branch L_fA
L_realA:
    s_mov_b64 s[18:19], -1
    s_mov_b64 exec, -1
    s_setprio 2
    s_mov_b32 s70, 0
L_lw13:
    ds_read_b32 v10, v0 offset:16
    s_add_u32 s70, s70, 1
    s_waitcnt lgkmcnt(0)
    v_readfirstlane_b32 s7, v10
    s_nop 0
    s_cmp_eq_u32 s7, 1032
    s_cbranch_scc1 L_lwd13
    s_sleep 2
    s_cmp_lt_u32 s70, 262144
    s_cbranch_scc1 L_lw13
L_lwd13:
    s_mov_b32 s70, 0
    s_mov_b64 s[20:21], -1
L_mA:
    buffer_load_dwordx4 v[20:23], v4, s[48:51], s16 offen sc1
    s_mov_b64 s[22:23], exec
    s_mov_b64 exec, s[20:21]
    buffer_load_dwordx4 v[16:19], v2, s[48:51], s77 offen sc1
    s_add_u32 s70, s70, 1
    s_cmp_ge_u32 s70, 65536
    s_cbranch_scc1 L_gotA
    s_waitcnt vmcnt(0)
    v_xor_b32 v16, s8, v16
    v_xor_b32 v17, s9, v17
    v_xor_b32 v18, s10, v18
    v_xor_b32 v19, s11, v19
    v_or3_b32 v10, v16, v17, v18
    v_or_b32 v10, v10, v19
    v_cmp_ne_u32_sdwa s[20:21], v10, v0 src0_sel:BYTE_0 src1_sel:DWORD
    s_mov_b64 exec, s[22:23]
    v_xor_b32 v20, s8, v20
    v_xor_b32 v21, s9, v21
    v_xor_b32 v22, s10, v22
    v_xor_b32 v23, s11, v23
    v_or3_b32 v10, v20, v21, v22
    v_or_b32 v10, v10, v23
    v_cmpx_ne_u32_sdwa vcc, v10, v0 src0_sel:BYTE_0 src1_sel:DWORD
    s_cbranch_execnz L_mA
    s_mov_b64 exec, s[20:21]
    buffer_load_dwordx4 v[16:19], v2, s[48:51], s77 offen sc1
    s_mov_b64 exec, s[18:19]
    s_nop 0
    v_max_f32_dpp v22, v20, v20 row_ror:8 row_mask:0xf bank_mask:0xf
    v_mov_b32 v23, v22
    s_nop 1
    v_permlane16_swap_b32 v22, v23
    v_max_f32 v22, v22, v23
    v_mov_b32 v23, v22
    s_nop 1
    v_permlane32_swap_b32 v22, v23
    v_max_f32 v22, v22, v23
    v_sub_f32 v20, v20, v22
    v_mul_f32 v20, s65, v20
    v_exp_f32 v20, v20
    s_nop 0
    v_mul_f32 v21, v21, v20
    s_nop 1
    v_add_f32_dpp v21, v21, v21 row_ror:8 row_mask:0xf bank_mask:0xf
    v_mov_b32 v23, v21
    s_nop 1
    v_permlane16_swap_b32 v21, v23
    v_add_f32 v21, v21, v23
    v_mov_b32 v23, v21
    s_nop 1
    v_permlane32_swap_b32 v21, v23
    v_add_f32 v21, v21, v23
    v_rcp_f32 v21, v21
    s_nop 0
    v_mul_f32 v20, v20, v21
    s_mov_b64 exec, s[20:21]
    s_cbranch_execz L_gotA
    s_branch L_fA2
L_fA:
    buffer_load_dwordx4 v[16:19], v2, s[48:51], s77 offen sc1
L_fA2:
    s_add_u32 s70, s70, 1
    s_cmp_ge_u32 s70, 65536
    s_cbranch_scc1 L_gotA
    s_waitcnt vmcnt(0)
    v_xor_b32 v16, s8, v16
    v_xor_b32 v17, s9, v17
    v_xor_b32 v18, s10, v18
    v_xor_b32 v19, s11, v19
    v_or3_b32 v10, v16, v17, v18
    v_or_b32 v10, v10, v19
    v_cmpx_ne_u32_sdwa vcc, v10, v0 src0_sel:BYTE_0 src1_sel:DWORD
    s_cbranch_execnz L_fA
L_gotA:
    s_mov_b64 exec, s[18:19]
    v_pk_mul_f32 v[16:17], v[16:17], v[20:21] op_sel_hi:[1,0]
    v_pk_mul_f32 v[18:19], v[18:19], v[20:21] op_sel_hi:[1,0]
    s_nop 0
    v_add_f32_dpp v16, v16, v16 row_ror:8 row_mask:0xf bank_mask:0xf
    v_add_f32_dpp v17, v17, v17 row_ror:8 row_mask:0xf bank_mask:0xf
    v_add_f32_dpp v18, v18, v18 row_ror:8 row_mask:0xf bank_mask:0xf
    v_add_f32_dpp v19, v19, v19 row_ror:8 row_mask:0xf bank_mask:0xf
    s_nop 0
    v_permlane32_swap_b32 v16, v18
    v_permlane32_swap_b32 v17, v19
    v_add_f32 v16, v16, v18
    v_add_f32 v17, v17, v19
    v_add_f32 v28, 0, v16
    v_add_f32 v29, 0, v17
    s_nop 0
    v_permlane16_swap_b32 v16, v28
    v_permlane16_swap_b32 v17, v29
    v_add_f32 v16, v16, v28
    v_add_f32 v17, v17, v29
    v_cvt_pk_bf16_f32 v24, v16, v17
    s_and_b32 exec_lo, s18, 0xff
    s_and_b32 exec_hi, s18, 0xff
    s_cmp_eq_u32 s71, 4
    s_cbranch_scc0 L_pA_x
    buffer_store_dwordx2 v[24:25], v6, s[48:51], s17 offen
    s_branch L_pA_d
L_pA_x:
    buffer_store_dwordx2 v[24:25], v6, s[48:51], s17 offen sc1
L_pA_d:
    s_mov_b64 exec, s[18:19]
    s_cbranch_execz L_realA
    s_mov_b32 s70, 0
L_f1:
    buffer_load_dwordx4 v[16:19], v3, s[48:51], s78 offen sc1
    s_add_u32 s70, s70, 1
    s_cmp_ge_u32 s70, 65536
    s_cbranch_scc1 L_got1
    s_waitcnt vmcnt(0)
    v_xor_b32 v17, s64, v17
    v_xor_b32 v19, s64, v19
    v_or_b32 v10, v17, v19
    v_cmpx_ne_u32 vcc, 0, v10
    s_cbranch_execnz L_f1
L_got1:
    s_mov_b64 exec, s[18:19]
    ds_write2_b32 v12, v16, v18 offset0:0 offset1:1
    s_waitcnt lgkmcnt(0)
    s_barrier
    s_branch L_fin
L_noA:
    s_cmp_ge_u32 s73, 4
    s_cbranch_scc1 L_red
    s_lshr_b32 s74, s75, 1
    v_and_b32 v11, 3, v1
    v_lshrrev_b32 v13, 4, v1
    v_bfe_u32 v14, v1, 2, 2
    v_mov_b32 v15, s67
    v_mov_b32 v4, v12
L_gu:
    s_lshl_b32 s7, s72, 1
    s_add_u32 s7, s7, s73
    s_sub_u32 s7, s7, 2
    s_cmp_ge_u32 s7, 7
    s_cbranch_scc1 L_fin
    s_mul_i32 s78, s4, 7
    s_add_u32 s78, s78, s7
    s_lshl_b32 s77, s4, 13
    s_lshl_b32 s7, s75, 10
    s_add_u32 s77, s77, s7
    s_add_u32 s77, s77, 1769472
    v_lshl_add_u32 v52, v13, 3, v14
    v_mul_u32_u24 v52, 1056, v52
    v_lshl_add_u32 v52, v11, 3, v52
    s_lshl_b32 s7, s75, 7
    s_add_u32 s7, s7, 114688
    v_add_u32 v52, s7, v52
    v_lshlrev_b32 v17, 6, v11
    v_lshl_add_u32 v17, v13, 4, v17
    v_add_u32 v17, 1536, v17
    v_mov_b32 v16, 128
    v_cmp_eq_u32 vcc, 0, v14
    s_nop 1
    v_cndmask_b32 v48, v16, v17, vcc
    v_cmp_eq_u32 vcc, 1, v14
    s_nop 1
    v_cndmask_b32 v49, v16, v17, vcc
    v_cmp_eq_u32 vcc, 2, v14
    s_nop 1
    v_cndmask_b32 v50, v16, v17, vcc
    v_cmp_eq_u32 vcc, 3, v14
    s_nop 1
    v_cndmask_b32 v51, v16, v17, vcc
    v_lshrrev_b32 v17, 1, v14
    v_lshl_add_u32 v17, v17, 2, v11
    v_mul_u32_u24 v6, 7168, v17
    v_and_b32 v17, 1, v14
    v_lshl_add_u32 v6, v17, 6, v6
    v_lshl_add_u32 v6, v13, 4, v6
    s_mul_i32 s17, s75, 57344
    s_lshl_b32 s7, s78, 7
    s_add_u32 s17, s17, s7
    s_add_u32 s17, s17, 917504
    s_mov_b32 s76, s77
    s_mov_b64 s[18:19], 0
    s_mov_b64 exec, 0
    s_mov_b32 s36, 1
    s_mov_b32 s70, 0
    s_branch L_f2
L_real2:
    s_mov_b64 s[18:19], -1
    s_mov_b64 exec, -1
    s_mov_b32 s70, 0
L_lw14:
    ds_read_b32 v10, v0 offset:24
    s_add_u32 s70, s70, 1
    s_waitcnt lgkmcnt(0)
    v_readfirstlane_b32 s7, v10
    s_nop 0
    s_cmp_eq_u32 s7, 1028
    s_cbranch_scc1 L_lwd14
    s_sleep 2
    s_cmp_lt_u32 s70, 262144
    s_cbranch_scc1 L_lw14
L_lwd14:
    ds_read_b64_tr_b16 v[80:81], v52 offset:0
    ds_read_b64_tr_b16 v[82:83], v52 offset:4224
    ds_read_b64_tr_b16 v[84:85], v52 offset:32
    ds_read_b64_tr_b16 v[86:87], v52 offset:4256
    ds_read_b64_tr_b16 v[88:89], v52 offset:64
    ds_read_b64_tr_b16 v[90:91], v52 offset:4288
    ds_read_b64_tr_b16 v[92:93], v52 offset:96
    ds_read_b64_tr_b16 v[94:95], v52 offset:4320
    s_xor_b32 s76, s77, 1024
    s_mov_b32 s70, 0
L_f2:
    buffer_load_dwordx4 v[16:19], v3, s[48:51], s77 offen sc1
    buffer_load_dwordx4 v[28:31], v3, s[48:51], s76 offen sc1
    s_add_u32 s70, s70, 1
    s_cmp_ge_u32 s70, 65536
    s_cbranch_scc1 L_got2
    s_waitcnt vmcnt(1)
    v_xor_b32 v17, s64, v17
    v_xor_b32 v19, s64, v19
    s_waitcnt vmcnt(0)
    v_xor_b32 v29, s64, v29
    v_xor_b32 v31, s64, v31
    v_or3_b32 v10, v17, v19, v29
    v_or_b32 v10, v10, v31
    v_cmpx_ne_u32 vcc, 0, v10
    s_cbranch_execnz L_f2
L_got2:
    s_mov_b64 exec, s[18:19]
    v_and_b32 v17, s68, v16
    v_and_b32 v19, s68, v18
    v_and_b32 v29, s68, v28
    v_and_b32 v31, s68, v30
    v_lshlrev_b32 v16, 16, v16
    v_lshlrev_b32 v18, 16, v18
    v_lshlrev_b32 v28, 16, v28
    v_lshlrev_b32 v30, 16, v30
    v_pk_add_f32 v[20:21], v[16:17], v[18:19]
    v_pk_mul_f32 v[22:23], v[16:17], v[16:17]
    v_pk_add_f32 v[24:25], v[28:29], v[30:31]
    v_pk_fma_f32 v[22:23], v[18:19], v[18:19], v[22:23]
    v_pk_add_f32 v[20:21], v[20:21], v[24:25]
    v_pk_fma_f32 v[22:23], v[28:29], v[28:29], v[22:23]
    v_add_f32 v24, v20, v21
    v_pk_fma_f32 v[22:23], v[30:31], v[30:31], v[22:23]
    v_add_f32 v25, v22, v23
    s_nop 1
    v_permlane32_swap_b32 v24, v25
    v_add_f32 v24, v24, v25
    s_nop 1
    v_add_f32_dpp v24, v24, v24 row_ror:1 row_mask:0xf bank_mask:0xf
    s_nop 1
    v_add_f32_dpp v24, v24, v24 row_ror:2 row_mask:0xf bank_mask:0xf
    s_nop 1
    v_add_f32_dpp v24, v24, v24 row_ror:4 row_mask:0xf bank_mask:0xf
    s_nop 1
    v_add_f32_dpp v24, v24, v24 row_ror:8 row_mask:0xf bank_mask:0xf
    v_mov_b32 v25, v24
    s_nop 1
    v_permlane16_swap_b32 v24, v25
    v_add_f32 v24, v24, v25
    v_mov_b32 v25, v24
    s_nop 1
    v_permlane32_swap_b32 v24, v25
    v_mul_f32 v24, 0x3b000000, v24
    v_mul_f32 v25, 0x3b000000, v25
    v_fma_f32 v25, -v24, v24, v25
    v_max_f32 v25, 0, v25
    v_cvt_pk_bf16_f32 v24, v24, v25
    v_and_b32 v25, s68, v24
    v_lshlrev_b32 v24, 16, v24
    v_add_f32 v25, 0x3727c5ac, v25
    v_sub_f32 v16, v16, v24
    v_cvt_pk_bf16_f32 v25, v25, v25
    v_sub_f32 v17, v17, v24
    v_and_b32 v25, s68, v25
    v_sub_f32 v18, v18, v24
    v_sqrt_f32 v25, v25
    v_sub_f32 v19, v19, v24
    v_cvt_pk_bf16_f32 v25, v25, v25
    v_cvt_pk_bf16_f32 v20, v16, v17
    v_and_b32 v25, s68, v25
    v_cvt_pk_bf16_f32 v21, v18, v19
    v_rcp_f32 v25, v25
    v_lshlrev_b32 v16, 16, v20
    v_and_b32 v17, s68, v20
    v_lshlrev_b32 v18, 16, v21
    v_and_b32 v19, s68, v21
    v_mul_f32 v16, v16, v25
    v_mul_f32 v17, v17, v25
    v_mul_f32 v18, v18, v25
    v_mul_f32 v19, v19, v25
    v_cvt_pk_bf16_f32 v20, v16, v17
    v_cvt_pk_bf16_f32 v21, v18, v19
    ds_write_b64 v4, v[20:21]
    s_waitcnt lgkmcnt(0)
    s_cbranch_execz L_skb0
    s_barrier
L_skb0:
    s_cbranch_execz L_skb1
    s_barrier
L_skb1:
    ds_read_b128 v[16:19], v48
    ds_read_b128 v[20:23], v49
    ds_read_b128 v[24:27], v50
    ds_read_b128 v[28:31], v51
    s_waitcnt lgkmcnt(3)
    v_mfma_f32_16x16x32_bf16 v[60:63], v[80:83], v[16:19], 0
    s_waitcnt lgkmcnt(2)
    v_mfma_f32_16x16x32_bf16 v[60:63], v[84:87], v[20:23], v[60:63]
    s_waitcnt lgkmcnt(1)
    v_mfma_f32_16x16x32_bf16 v[60:63], v[88:91], v[24:27], v[60:63]
    s_waitcnt lgkmcnt(0)
    v_mfma_f32_16x16x32_bf16 v[60:63], v[92:95], v[28:31], v[60:63]
    s_nop 7
    v_and_or_b32 v60, v60, v15, s8
    v_and_or_b32 v61, v61, v15, s9
    v_and_or_b32 v62, v62, v15, s10
    v_and_or_b32 v63, v63, v15, s11
    buffer_store_dwordx4 v[60:63], v6, s[48:51], s17 offen sc1
    s_cbranch_execz L_real2
    s_cmp_lg_u32 s3, 0
    s_cbranch_scc1 L_nolb
    s_cmp_lg_u32 s5, 2
    s_cbranch_scc1 L_nolb
    v_mov_b32 v16, s64
    s_lshl_b32 s7, s4, 5
    s_add_u32 s7, s7, s5
    s_lshl_b32 s7, s7, 7
    s_add_u32 s7, s7, 32832
    s_mov_b64 exec, 1
    s_cmp_eq_u32 s71, 4
    s_cbranch_scc0 L_lbx
    buffer_store_dword v16, v0, s[48:51], s7 offen
    s_branch L_nolb
L_lbx:
    buffer_store_dword v16, v0, s[48:51], s7 offen sc1
L_nolb:
    s_branch L_fin
L_gemvw:
    s_cmp_ge_u32 s73, 4
    s_cbranch_scc1 L_fin
    s_sub_u32 s75, s3, 12
    v_and_b32 v11, 3, v1
    v_lshrrev_b32 v13, 4, v1
    v_bfe_u32 v14, v1, 2, 2
    v_mul_u32_u24 v5, 1088, v11
    v_lshl_add_u32 v5, v13, 4, v5
    v_add_u32 v5, 3072, v5
    s_lshl_b32 s16, s72, 1
    s_add_u32 s16, s16, s73
    s_cmp_ge_u32 s73, 2
    s_cbranch_scc1 L_gemv_gu
    v_lshlrev_b32 v12, 10, v13
    v_lshl_add_u32 v12, v14, 7, v12
    v_lshl_add_u32 v12, v11, 3, v12
    s_lshl_b32 s7, s75, 5
    s_add_u32 s7, s7, 16384
    v_add_u32 v12, s7, v12
    s_mov_b32 s70, 0
L_lw15:
    ds_read_b32 v10, v0 offset:16
    s_add_u32 s70, s70, 1
    s_waitcnt lgkmcnt(0)
    v_readfirstlane_b32 s7, v10
    s_nop 0
    s_cmp_eq_u32 s7, 1032
    s_cbranch_scc1 L_lwd15
    s_cmp_lt_u32 s70, 262144
    s_cbranch_scc1 L_lw15
L_lwd15:
    ds_read_b64_tr_b16 v[64:65], v12 offset:0
    ds_read_b64_tr_b16 v[66:67], v12 offset:512
    ds_read_b64_tr_b16 v[68:69], v12 offset:4096
    ds_read_b64_tr_b16 v[70:71], v12 offset:4608
    ds_read_b64_tr_b16 v[72:73], v12 offset:8192
    ds_read_b64_tr_b16 v[74:75], v12 offset:8704
    ds_read_b64_tr_b16 v[76:77], v12 offset:12288
    ds_read_b64_tr_b16 v[78:79], v12 offset:12800
    ds_read_b64_tr_b16 v[80:81], v12 offset:16384
    ds_read_b64_tr_b16 v[82:83], v12 offset:16896
    ds_read_b64_tr_b16 v[84:85], v12 offset:20480
    ds_read_b64_tr_b16 v[86:87], v12 offset:20992
    ds_read_b64_tr_b16 v[88:89], v12 offset:24576
    ds_read_b64_tr_b16 v[90:91], v12 offset:25088
    ds_read_b64_tr_b16 v[92:93], v12 offset:28672
    ds_read_b64_tr_b16 v[94:95], v12 offset:29184
    ds_read_b64_tr_b16 v[96:97], v12 offset:32768
    ds_read_b64_tr_b16 v[98:99], v12 offset:33280
    ds_read_b64_tr_b16 v[100:101], v12 offset:36864
    ds_read_b64_tr_b16 v[102:103], v12 offset:37376
    ds_read_b64_tr_b16 v[104:105], v12 offset:40960
    ds_read_b64_tr_b16 v[106:107], v12 offset:41472
    ds_read_b64_tr_b16 v[108:109], v12 offset:45056
    ds_read_b64_tr_b16 v[110:111], v12 offset:45568
    ds_read_b64_tr_b16 v[112:113], v12 offset:49152
    ds_read_b64_tr_b16 v[114:115], v12 offset:49664
    ds_read_b64_tr_b16 v[116:117], v12 offset:53248
    ds_read_b64_tr_b16 v[118:119], v12 offset:53760
    ds_read_b64_tr_b16 v[120:121], v12 offset:57344
    ds_read_b64_tr_b16 v[122:123], v12 offset:57856
    ds_read_b64_tr_b16 v[124:125], v12 offset:61440
    ds_read_b64_tr_b16 v[126:127], v12 offset:61952
    v_mov_b32 v57, s64
    v_lshlrev_b32 v6, 6, v11
    v_lshl_add_u32 v6, v13, 4, v6
    v_lshl_add_u32 v6, v14, 3, v6
    v_cmp_eq_u32 vcc, 1, v14
    s_lshl_b32 s17, s4, 3
    s_xor_b32 s16, s16, 4
    s_add_u32 s17, s17, s16
    s_lshl_b32 s17, s17, 10
    s_lshl_b32 s7, s75, 8
    s_add_u32 s17, s17, s7
    s_add_u32 s17, s17, 65536
    s_waitcnt lgkmcnt(0)
    s_barrier
    ds_read_b128 v[16:19], v5 offset:0
    ds_read_b128 v[20:23], v5 offset:64
    ds_read_b128 v[24:27], v5 offset:128
    ds_read_b128 v[28:31], v5 offset:192
    ds_read_b128 v[32:35], v5 offset:256
    ds_read_b128 v[36:39], v5 offset:320
    ds_read_b128 v[40:43], v5 offset:384
    ds_read_b128 v[44:47], v5 offset:448
    s_waitcnt lgkmcnt(7)
    v_mfma_f32_16x16x32_bf16 v[60:63], v[64:67], v[16:19], 0
    ds_read_b128 v[16:19], v5 offset:512
    s_waitcnt lgkmcnt(7)
    v_mfma_f32_16x16x32_bf16 v[60:63], v[68:71], v[20:23], v[60:63]
    ds_read_b128 v[20:23], v5 offset:576
    s_waitcnt lgkmcnt(7)
    v_mfma_f32_16x16x32_bf16 v[60:63], v[72:75], v[24:27], v[60:63]
    ds_read_b128 v[24:27], v5 offset:640
    s_waitcnt lgkmcnt(7)
    v_mfma_f32_16x16x32_bf16 v[60:63], v[76:79], v[28:31], v[60:63]
    ds_read_b128 v[28:31], v5 offset:704
    s_waitcnt lgkmcnt(7)
    v_mfma_f32_16x16x32_bf16 v[60:63], v[80:83], v[32:35], v[60:63]
    ds_read_b128 v[32:35], v5 offset:768
    s_waitcnt lgkmcnt(7)
    v_mfma_f32_16x16x32_bf16 v[60:63], v[84:87], v[36:39], v[60:63]
    ds_read_b128 v[36:39], v5 offset:832
    s_waitcnt lgkmcnt(7)
    v_mfma_f32_16x16x32_bf16 v[60:63], v[88:91], v[40:43], v[60:63]
    ds_read_b128 v[40:43], v5 offset:896
    s_waitcnt lgkmcnt(7)
    v_mfma_f32_16x16x32_bf16 v[60:63], v[92:95], v[44:47], v[60:63]
    ds_read_b128 v[44:47], v5 offset:960
    s_waitcnt lgkmcnt(7)
    v_mfma_f32_16x16x32_bf16 v[60:63], v[96:99], v[16:19], v[60:63]
    s_waitcnt lgkmcnt(6)
    v_mfma_f32_16x16x32_bf16 v[60:63], v[100:103], v[20:23], v[60:63]
    s_waitcnt lgkmcnt(5)
    v_mfma_f32_16x16x32_bf16 v[60:63], v[104:107], v[24:27], v[60:63]
    s_waitcnt lgkmcnt(4)
    v_mfma_f32_16x16x32_bf16 v[60:63], v[108:111], v[28:31], v[60:63]
    s_waitcnt lgkmcnt(3)
    v_mfma_f32_16x16x32_bf16 v[60:63], v[112:115], v[32:35], v[60:63]
    s_waitcnt lgkmcnt(2)
    v_mfma_f32_16x16x32_bf16 v[60:63], v[116:119], v[36:39], v[60:63]
    s_waitcnt lgkmcnt(1)
    v_mfma_f32_16x16x32_bf16 v[60:63], v[120:123], v[40:43], v[60:63]
    s_waitcnt lgkmcnt(0)
    v_mfma_f32_16x16x32_bf16 v[60:63], v[124:127], v[44:47], v[60:63]
    s_mov_b32 exec_lo, 0xff00ff
    s_mov_b32 exec_hi, 0xff00ff
    s_nop 5
    v_cvt_pk_bf16_f32 v60, v60, v61
    v_cvt_pk_bf16_f32 v62, v62, v63
    v_cndmask_b32 v56, v60, v62, vcc
    buffer_atomic_swap_x2 v[56:57], v6, s[48:51], s17 offen sc1
    s_branch L_fin
L_gemv_gu:
    s_cmp_ge_u32 s16, 9
    s_cbranch_scc1 L_fin
    v_lshlrev_b32 v12, 9, v13
    v_lshl_add_u32 v12, v14, 6, v12
    v_and_b32 v17, 1, v1
    v_lshl_add_u32 v12, v17, 3, v12
    v_bfe_u32 v17, v1, 1, 1
    v_lshl_add_u32 v12, v17, 12, v12
    s_lshl_b32 s7, s75, 4
    s_add_u32 s7, s7, 16384
    v_add_u32 v12, s7, v12
    s_mov_b32 s70, 0
L_lw16:
    ds_read_b32 v10, v0 offset:20
    s_add_u32 s70, s70, 1
    s_waitcnt lgkmcnt(0)
    v_readfirstlane_b32 s7, v10
    s_nop 0
    s_cmp_eq_u32 s7, 4
    s_cbranch_scc1 L_lwd16
    s_sleep 1
    s_cmp_lt_u32 s70, 262144
    s_cbranch_scc1 L_lw16
L_lwd16:
    s_sleep 8
    s_call_b64 s[76:77], L_guload
    v_and_b32 v11, 3, v1
    v_mov_b32 v50, 1
    v_mov_b32 v51, 0x100
    v_lshlrev_b32 v53, 6, v11
    v_lshl_add_u32 v53, v13, 3, v53
    v_lshl_add_u32 v53, v14, 1, v53
    s_lshl_b32 s7, s75, 4
    v_add_u32 v53, s7, v53
    v_cmp_eq_u32 s[12:13], 1, v14
    v_cmp_lt_u32 vcc, 1, v14
    v_cmp_eq_u32 s[38:39], 3, v14
    s_mov_b64 exec, 0
    s_branch L_gg_post
L_gg_real:
    s_waitcnt vmcnt(8)
    s_mov_b64 exec, 1
    ds_add_u32 v0, v50 offset:24
    s_mov_b64 exec, -1
    s_mov_b32 s70, 0
L_lw17:
    ds_read_b32 v10, v0 offset:24
    s_add_u32 s70, s70, 1
    s_waitcnt lgkmcnt(0)
    v_readfirstlane_b32 s37, v10
    s_nop 0
    s_and_b32 s7, s37, 0xff
    s_cmp_eq_u32 s7, 4
    s_cbranch_scc1 L_lwd17
    s_cmp_lt_u32 s70, 262144
    s_cbranch_scc1 L_lw17
L_lwd17:
    ds_read_b64_tr_b16 v[64:65], v12 offset:0
    ds_read_b64_tr_b16 v[66:67], v12 offset:256
    ds_read_b64_tr_b16 v[68:69], v12 offset:2048
    ds_read_b64_tr_b16 v[70:71], v12 offset:2304
    ds_read_b64_tr_b16 v[72:73], v12 offset:8192
    ds_read_b64_tr_b16 v[74:75], v12 offset:8448
    ds_read_b64_tr_b16 v[76:77], v12 offset:10240
    ds_read_b64_tr_b16 v[78:79], v12 offset:10496
    ds_read_b64_tr_b16 v[80:81], v12 offset:16384
    ds_read_b64_tr_b16 v[82:83], v12 offset:16640
    ds_read_b64_tr_b16 v[84:85], v12 offset:18432
    ds_read_b64_tr_b16 v[86:87], v12 offset:18688
    ds_read_b64_tr_b16 v[88:89], v12 offset:24576
    ds_read_b64_tr_b16 v[90:91], v12 offset:24832
    ds_read_b64_tr_b16 v[92:93], v12 offset:26624
    ds_read_b64_tr_b16 v[94:95], v12 offset:26880
    ds_read_b64_tr_b16 v[96:97], v12 offset:32768
    ds_read_b64_tr_b16 v[98:99], v12 offset:33024
    ds_read_b64_tr_b16 v[100:101], v12 offset:34816
    ds_read_b64_tr_b16 v[102:103], v12 offset:35072
    ds_read_b64_tr_b16 v[104:105], v12 offset:40960
    ds_read_b64_tr_b16 v[106:107], v12 offset:41216
    ds_read_b64_tr_b16 v[108:109], v12 offset:43008
    ds_read_b64_tr_b16 v[110:111], v12 offset:43264
    ds_read_b64_tr_b16 v[112:113], v12 offset:49152
    ds_read_b64_tr_b16 v[114:115], v12 offset:49408
    ds_read_b64_tr_b16 v[116:117], v12 offset:51200
    ds_read_b64_tr_b16 v[118:119], v12 offset:51456
    ds_read_b64_tr_b16 v[120:121], v12 offset:57344
    ds_read_b64_tr_b16 v[122:123], v12 offset:57600
    ds_read_b64_tr_b16 v[124:125], v12 offset:59392
    ds_read_b64_tr_b16 v[126:127], v12 offset:59648
    s_waitcnt vmcnt(0)
    s_mov_b64 exec, 1
    ds_add_u32 v0, v51 offset:24
    s_mov_b64 exec, -1
    s_waitcnt lgkmcnt(0)
    s_barrier
L_gg_post:
    ds_read_b128 v[16:19], v5 offset:0
    ds_read_b128 v[20:23], v5 offset:64
    ds_read_b128 v[24:27], v5 offset:128
    ds_read_b128 v[28:31], v5 offset:192
    ds_read_b128 v[32:35], v5 offset:256
    ds_read_b128 v[36:39], v5 offset:320
    ds_read_b128 v[40:43], v5 offset:384
    ds_read_b128 v[44:47], v5 offset:448
    s_waitcnt lgkmcnt(7)
    v_mfma_f32_16x16x32_bf16 v[60:63], v[64:67], v[16:19], 0
    ds_read_b128 v[16:19], v5 offset:512
    s_waitcnt lgkmcnt(7)
    v_mfma_f32_16x16x32_bf16 v[60:63], v[68:71], v[20:23], v[60:63]
    ds_read_b128 v[20:23], v5 offset:576
    s_waitcnt lgkmcnt(7)
    v_mfma_f32_16x16x32_bf16 v[60:63], v[72:75], v[24:27], v[60:63]
    ds_read_b128 v[24:27], v5 offset:640
    s_waitcnt lgkmcnt(7)
    v_mfma_f32_16x16x32_bf16 v[60:63], v[76:79], v[28:31], v[60:63]
    ds_read_b128 v[28:31], v5 offset:704
    s_waitcnt lgkmcnt(7)
    v_mfma_f32_16x16x32_bf16 v[60:63], v[80:83], v[32:35], v[60:63]
    ds_read_b128 v[32:35], v5 offset:768
    s_waitcnt lgkmcnt(7)
    v_mfma_f32_16x16x32_bf16 v[60:63], v[84:87], v[36:39], v[60:63]
    ds_read_b128 v[36:39], v5 offset:832
    s_waitcnt lgkmcnt(7)
    v_mfma_f32_16x16x32_bf16 v[60:63], v[88:91], v[40:43], v[60:63]
    ds_read_b128 v[40:43], v5 offset:896
    s_waitcnt lgkmcnt(7)
    v_mfma_f32_16x16x32_bf16 v[60:63], v[92:95], v[44:47], v[60:63]
    ds_read_b128 v[44:47], v5 offset:960
    s_waitcnt lgkmcnt(7)
    v_mfma_f32_16x16x32_bf16 v[60:63], v[96:99], v[16:19], v[60:63]
    s_waitcnt lgkmcnt(6)
    v_mfma_f32_16x16x32_bf16 v[60:63], v[100:103], v[20:23], v[60:63]
    s_waitcnt lgkmcnt(5)
    v_mfma_f32_16x16x32_bf16 v[60:63], v[104:107], v[24:27], v[60:63]
    s_waitcnt lgkmcnt(4)
    v_mfma_f32_16x16x32_bf16 v[60:63], v[108:111], v[28:31], v[60:63]
    s_waitcnt lgkmcnt(3)
    v_mfma_f32_16x16x32_bf16 v[60:63], v[112:115], v[32:35], v[60:63]
    s_waitcnt lgkmcnt(2)
    v_mfma_f32_16x16x32_bf16 v[60:63], v[116:119], v[36:39], v[60:63]
    s_waitcnt lgkmcnt(1)
    v_mfma_f32_16x16x32_bf16 v[60:63], v[120:123], v[40:43], v[60:63]
    s_waitcnt lgkmcnt(0)
    v_mfma_f32_16x16x32_bf16 v[60:63], v[124:127], v[44:47], v[60:63]
    s_nop 7
    v_cndmask_b32 v60, v60, v61, s[12:13]
    v_cndmask_b32 v62, v62, v63, s[38:39]
    v_cndmask_b32 v16, v60, v62, vcc
    v_cvt_pk_bf16_f32 v16, v16, v16
    v_and_b32 v16, s68, v16
    v_mul_f32 v17, s69, v16
    v_mov_b32 v18, v16
    v_exp_f32 v17, v17
    v_mov_b32 v19, v16
    v_add_f32 v17, 1.0, v17
    s_nop 0
    v_permlane32_swap_b32 v18, v19
    v_rcp_f32 v17, v17
    s_nop 0
    v_mul_f32 v17, v16, v17
    v_cvt_pk_bf16_f32 v17, v17, v17
    v_and_b32 v17, s68, v17
    v_mul_f32 v17, v17, v19
    v_cvt_pk_bf16_f32 v17, v17, v17
    s_mov_b32 exec_hi, 0
    ds_write_b16 v53, v17 offset:1536
    s_waitcnt lgkmcnt(0)
    s_cbranch_execz L_gg_real
    s_barrier
L_skb2:
    s_branch L_fin
L_red:
    s_mov_b32 s56, s34
    s_mov_b32 s57, s35
    s_mov_b32 s58, 0x1000
    s_mov_b32 s59, 0x20000
    s_cmp_ge_u32 s3, 4
    s_cbranch_scc1 L_hA
    s_cmp_lg_u32 s3, 2
    s_cbranch_scc1 L_fin
    s_lshl_b32 s77, s4, 2
    s_add_u32 s77, s77, s72
    s_sub_u32 s78, s73, 4
    v_and_b32 v11, 3, v1
    v_lshrrev_b32 v13, 4, v1
    v_lshlrev_b32 v4, 3, v11
    v_lshl_add_u32 v4, v13, 1, v4
    s_lshl_b32 s79, s78, 10
    s_lshl_b32 s7, s77, 5
    s_add_u32 s79, s79, s7
    v_lshrrev_b32 v10, 2, v1
    v_lshlrev_b32 v2, 4, v11
    v_lshrrev_b32 v5, 5, v1
    v_lshl_add_u32 v2, v5, 3, v2
    s_lshl_b32 s16, s79, 1
    s_lshl_b32 s7, s4, 13
    s_add_u32 s16, s16, s7
    s_add_u32 s16, s16, 1769472
    v_and_b32 v5, 1, v13
    v_lshlrev_b32 v5, 4, v5
    v_lshlrev_b32 v6, 7, v10
    v_lshl_add_u32 v6, v11, 4, v6
    s_lshr_b32 s7, s77, 1
    s_lshl_b32 s7, s7, 2
    s_add_u32 s7, s7, s78
    s_mul_i32 s17, s7, 7168
    s_and_b32 s7, s77, 1
    s_lshl_b32 s7, s7, 6
    s_add_u32 s17, s17, s7
    s_add_u32 s17, s17, 917504
    v_mov_b32 v7, s64
    v_mov_b32 v28, 0
    v_mov_b32 v29, 0
    v_mov_b32 v30, 0
    v_mov_b32 v31, 0
    v_mov_b32 v48, 0
    v_mov_b32 v49, 0
    v_mov_b32 v50, 0
    v_mov_b32 v51, 0
    s_mov_b64 s[18:19], 0
    s_mov_b64 exec, 0
    s_mov_b32 s36, 1
    s_mov_b32 s70, 0
    s_branch L_got3
L_real3:
    s_mov_b64 s[18:19], -1
    s_mov_b64 exec, -1
    s_mov_b32 s70, 0
L_lw18:
    ds_read_b32 v10, v0 offset:20
    s_add_u32 s70, s70, 1
    s_waitcnt lgkmcnt(0)
    v_readfirstlane_b32 s7, v10
    s_nop 0
    s_cmp_eq_u32 s7, 4
    s_cbranch_scc1 L_lwd18
    s_sleep 8
    s_cmp_lt_u32 s70, 262144
    s_cbranch_scc1 L_lw18
L_lwd18:
    s_mov_b32 s70, 0
L_f4:
    buffer_load_dwordx2 v[48:49], v2, s[48:51], s16 offen sc1
    s_add_u32 s70, s70, 1
    s_cmp_ge_u32 s70, 65536
    s_cbranch_scc1 L_got4
    s_waitcnt vmcnt(0)
    v_cmpx_ne_u32 vcc, s64, v49
    s_cbranch_execnz L_f4
L_got4:
    s_mov_b64 exec, -1
    v_lshrrev_b32 v48, v5, v48
    v_lshlrev_b32 v48, 16, v48
    s_lshl_b32 s7, s4, 12
    s_add_u32 s7, s7, 33088
    s_mov_b32 s70, 0
    s_mov_b64 exec, 1
L_f5:
    buffer_load_dword v10, v0, s[48:51], s7 offen sc1
    s_add_u32 s70, s70, 1
    s_cmp_ge_u32 s70, 65536
    s_cbranch_scc1 L_got5
    s_waitcnt vmcnt(0)
    v_cmpx_ne_u32 vcc, s64, v10
    s_cbranch_execnz L_f5
L_got5:
    s_mov_b64 exec, -1
    s_sleep 3
    s_add_u32 s16, s17, 4096
    s_mov_b32 s70, 0
    s_mov_b64 s[20:21], -1
L_p3:
    s_mov_b64 exec, s[20:21]
    buffer_load_dwordx4 v[16:19], v6, s[48:51], s17 offen sc1
    buffer_load_dwordx4 v[20:23], v6, s[48:51], s17 offen offset:2048 sc1
    buffer_load_dwordx4 v[24:27], v6, s[48:51], s16 offen sc1
    s_mov_b32 exec_hi, 0
    buffer_load_dwordx4 v[28:31], v6, s[48:51], s16 offen offset:2048 sc1
    s_mov_b64 exec, s[20:21]
    s_add_u32 s70, s70, 1
    s_cmp_ge_u32 s70, 65536
    s_cbranch_scc1 L_got3
    s_waitcnt vmcnt(3)
    v_xor_b32 v16, s8, v16
    v_xor_b32 v17, s9, v17
    v_xor_b32 v18, s10, v18
    v_xor_b32 v19, s11, v19
    v_or3_b32 v10, v16, v17, v18
    s_waitcnt vmcnt(2)
    v_xor_b32 v20, s8, v20
    v_xor_b32 v21, s9, v21
    v_xor_b32 v22, s10, v22
    v_xor_b32 v23, s11, v23
    v_or3_b32 v10, v10, v19, v20
    v_or3_b32 v10, v10, v21, v22
    s_waitcnt vmcnt(1)
    v_xor_b32 v24, s8, v24
    v_xor_b32 v25, s9, v25
    v_xor_b32 v26, s10, v26
    v_xor_b32 v27, s11, v27
    v_or3_b32 v10, v10, v23, v24
    v_or3_b32 v10, v10, v25, v26
    v_or_b32 v10, v10, v27
    s_mov_b32 exec_hi, 0
    s_waitcnt vmcnt(0)
    v_xor_b32 v28, s8, v28
    v_xor_b32 v29, s9, v29
    v_xor_b32 v30, s10, v30
    v_xor_b32 v31, s11, v31
    v_or3_b32 v10, v10, v28, v29
    v_or3_b32 v10, v10, v30, v31
    s_mov_b64 exec, s[20:21]
    v_cmpx_ne_u32_sdwa s[20:21], v10, v0 src0_sel:BYTE_0 src1_sel:DWORD
    s_cbranch_execnz L_p3
L_got3:
    s_mov_b64 exec, s[18:19]
    v_pk_add_f32 v[16:17], v[16:17], v[20:21]
    v_pk_add_f32 v[18:19], v[18:19], v[22:23]
    v_pk_add_f32 v[24:25], v[24:25], v[28:29]
    v_pk_add_f32 v[26:27], v[26:27], v[30:31]
    v_pk_add_f32 v[16:17], v[16:17], v[24:25]
    v_pk_add_f32 v[18:19], v[18:19], v[26:27]
    s_nop 1
    v_permlane32_swap_b32 v16, v18
    v_permlane32_swap_b32 v17, v19
    v_add_f32 v16, v16, v18
    v_add_f32 v17, v17, v19
    s_nop 1
    v_permlane16_swap_b32 v16, v17
    v_add_f32 v16, v16, v17
    s_nop 1
    v_add_f32_dpp v16, v16, v16 row_ror:8 row_mask:0xf bank_mask:0xf
    s_nop 1
    v_add_f32_dpp v16, v16, v16 row_ror:4 row_mask:0xf bank_mask:0xf
    v_cvt_pk_bf16_f32 v16, v16, v16
    v_and_b32 v16, s68, v16
    v_add_f32 v16, v16, v48
    v_cvt_pk_bf16_f32 v16, v16, v16
    s_and_b32 exec_lo, s18, 0x000f000f
    s_and_b32 exec_hi, s18, 0x000f000f
    buffer_store_short v16, v4, s[56:59], s79 offen
    s_cbranch_execz L_real3
    s_cmp_lg_u32 s79, 0
    s_cbranch_scc1 L_fin
    s_mov_b64 exec, 1
    buffer_store_dword v7, v0, s[48:51], 0 offen sc1
    s_branch L_fin
L_hA:
    s_sub_u32 s74, s73, 4
    s_lshl_b32 s74, s74, 2
    s_add_u32 s74, s74, s3
    s_sub_u32 s74, s74, 4
    v_lshrrev_b32 v11, 3, v1
    v_and_b32 v13, 7, v1
    v_lshrrev_b32 v10, 5, v1
    v_lshlrev_b32 v6, 3, v13
    v_lshl_add_u32 v2, v11, 13, v6
    v_lshl_add_u32 v6, v10, 6, v6
    s_lshl_b32 s77, s74, 9
    s_lshl_b32 s7, s72, 6
    s_add_u32 s77, s77, s7
    s_add_u32 s77, s77, 65536
    v_lshrrev_b32 v10, 1, v6
    s_lshl_b32 s7, s72, 10
    s_lshl_b32 s15, s74, 6
    s_add_u32 s7, s7, s15
    buffer_load_dword v8, v10, s[60:63], s7 offen
    s_lshl_b32 s17, s7, 1
    s_lshl_b32 s7, s4, 13
    s_add_u32 s17, s17, s7
    s_add_u32 s17, s17, 1769472
    v_mov_b32 v25, s64
    v_mov_b32 v27, s64
    s_mov_b64 s[18:19], 0
    s_mov_b64 exec, 0
    s_mov_b32 s36, 1
    s_mov_b32 s70, 0
    s_branch L_fH
L_realH:
    s_mov_b64 s[18:19], -1
    s_mov_b64 exec, -1
    s_mov_b32 s70, 0
L_lw19:
    ds_read_b32 v10, v0 offset:20
    s_add_u32 s70, s70, 1
    s_waitcnt lgkmcnt(0)
    v_readfirstlane_b32 s7, v10
    s_nop 0
    s_cmp_eq_u32 s7, 4
    s_cbranch_scc1 L_lwd19
    s_sleep 4
    s_cmp_lt_u32 s70, 262144
    s_cbranch_scc1 L_lw19
L_lwd19:
    s_waitcnt vmcnt(0)
    v_lshlrev_b32 v30, 16, v8
    v_and_b32 v31, s68, v8
    s_sleep 16
    s_mov_b32 s70, 0
L_fH:
    v_mov_b32 v16, 0
    v_mov_b32 v17, 0
    v_mov_b32 v18, 0
    v_mov_b32 v19, 0
    buffer_atomic_or_x2 v[16:17], v2, s[48:51], s77 offen sc0 sc1
    buffer_atomic_or_x2 v[18:19], v2, s[48:51], s77 offen offset:256 sc0 sc1
    s_add_u32 s70, s70, 1
    s_cmp_ge_u32 s70, 65536
    s_cbranch_scc1 L_gotH
    s_waitcnt vmcnt(0)
    v_xor_b32 v17, s64, v17
    v_xor_b32 v19, s64, v19
    v_or_b32 v10, v17, v19
    v_cmpx_ne_u32 vcc, 0, v10
    s_cbranch_execnz L_fH
L_gotH:
    s_mov_b64 exec, s[18:19]
    v_and_b32 v17, s68, v16
    v_and_b32 v19, s68, v18
    v_lshlrev_b32 v16, 16, v16
    v_lshlrev_b32 v18, 16, v18
    s_nop 0
    v_add_f32_dpp v16, v16, v16 row_ror:8 row_mask:0xf bank_mask:0xf
    v_add_f32_dpp v17, v17, v17 row_ror:8 row_mask:0xf bank_mask:0xf
    v_add_f32_dpp v18, v18, v18 row_ror:8 row_mask:0xf bank_mask:0xf
    v_add_f32_dpp v19, v19, v19 row_ror:8 row_mask:0xf bank_mask:0xf
    s_nop 0
    v_permlane32_swap_b32 v16, v18
    v_permlane32_swap_b32 v17, v19
    v_add_f32 v16, v16, v18
    v_add_f32 v17, v17, v19
    v_add_f32 v28, 0, v16
    v_add_f32 v29, 0, v17
    s_nop 0
    v_permlane16_swap_b32 v16, v28
    v_permlane16_swap_b32 v17, v29
    v_add_f32 v16, v16, v28
    v_add_f32 v17, v17, v29
    v_cvt_pk_bf16_f32 v20, v16, v17
    v_lshlrev_b32 v16, 16, v20
    v_and_b32 v17, s68, v20
    v_pk_add_f32 v[16:17], v[16:17], v[30:31]
    v_cvt_pk_bf16_f32 v24, v16, v17
    s_and_b32 exec_lo, s18, 0xff
    s_and_b32 exec_hi, s18, 0xff
    s_cmp_eq_u32 s71, 4
    s_cbranch_scc0 L_pH_x
    buffer_store_dwordx2 v[24:25], v6, s[48:51], s17 offen
    s_branch L_pH_d
L_pH_x:
    buffer_store_dwordx2 v[24:25], v6, s[48:51], s17 offen sc1
L_pH_d:
    s_mov_b64 exec, s[18:19]
    s_cbranch_execz L_realH
    s_branch L_fin
L_qissue:
    s_setprio 3
    v_bfe_u32 v112, v1, 2, 2
    v_lshlrev_b32 v112, 9, v112
    v_lshrrev_b32 v113, 4, v1
    v_lshl_add_u32 v112, v113, 7, v112
    v_and_b32 v113, 3, v1
    v_lshl_add_u32 v112, v113, 5, v112
    s_lshl_b32 s15, s4, 15
    s_lshl_b32 s7, s72, 13
    s_add_u32 s15, s15, s7
    s_lshl_b32 s7, s3, 11
    s_add_u32 s15, s15, s7
    s_add_u32 s15, s15, 655360
    v_lshl_add_u32 v113, v1, 5, s7
    v_mov_b32 v116, 1
    s_mov_b32 s64, s6
L_tagok_q:
    s_mul_i32 s64, s64, 0x9E3779B1
    s_add_u32 s64, s64, 0x7F4A7C15
    s_and_b32 s8, s64, 0xff
    s_bfe_u32 s9, s64, 0x80008
    s_cmp_eq_u32 s8, s9
    s_cbranch_scc1 L_tagok_q
    s_bfe_u32 s10, s64, 0x80010
    s_lshr_b32 s11, s64, 24
    s_sleep 10
    s_mov_b32 s70, 0
L_pollq:
    s_and_b32 s7, s70, 3
    s_cmp_eq_u32 s7, 3
    s_cselect_b32 s7, 0, 786432
    s_add_u32 s7, s7, s15
    buffer_load_dwordx4 v[104:107], v112, s[48:51], s7 offen sc1
    buffer_load_dwordx4 v[108:111], v112, s[48:51], s7 offen offset:16 sc1
    ds_write_b32 v0, v116 offset:12
    s_add_u32 s70, s70, 1
    s_waitcnt vmcnt(0)
    v_xor_b32 v104, s8, v104
    v_xor_b32 v105, s9, v105
    v_xor_b32 v106, s10, v106
    v_xor_b32 v107, s11, v107
    v_xor_b32 v108, s8, v108
    v_xor_b32 v109, s9, v109
    v_xor_b32 v110, s10, v110
    v_xor_b32 v111, s11, v111
    v_or3_b32 v114, v104, v105, v106
    v_or3_b32 v114, v114, v108, v109
    v_or_b32 v114, v114, v110
    v_and_b32 v114, 0xff, v114
    v_or_b32 v115, v107, v111
    v_and_b32 v115, 0xf0, v115
    v_or_b32 v114, v114, v115
    v_cmp_ne_u32 vcc, 0, v114
    s_nop 0
    s_and_b64 exec, exec, vcc
    s_cbranch_execz L_gotq_h
    s_cmp_lt_u32 s70, 65536
    s_cbranch_scc1 L_pollq
L_gotq_h:
    s_mov_b64 exec, -1
    v_and_b32 v114, 0xf, v107
    v_cmp_ne_u32 vcc, s79, v114
    v_and_b32 v107, s67, v107
    v_and_b32 v111, s67, v111
    ds_write_b128 v113, v[104:107] offset:8192
    ds_write_b128 v113, v[108:111] offset:8208
    s_cmp_eq_u64 vcc, 0
    s_cselect_b32 s7, 1, 0x101
    v_mov_b32 v114, s7
    s_mov_b64 exec, 1
    ds_add_u32 v0, v114
    s_mov_b64 exec, -1
    s_mov_b32 s74, 0
    s_setpc_b64 s[76:77]
L_wload:
    s_cmp_ge_u32 s73, 4
    s_cbranch_scc1 L_wret
    s_sub_u32 s74, s3, 4
    s_cmp_ge_u32 s73, 2
    s_cbranch_scc1 L_wret
    s_cmp_ge_u32 s74, 4
    s_cbranch_scc1 L_wret
    s_mov_b32 s52, s24
    s_mov_b32 s53, s25
    s_mov_b32 s54, 0x400000
    s_mov_b32 s55, 0x20000
    v_lshrrev_b32 v11, 3, v1
    v_lshlrev_b32 v11, 10, v11
    v_and_b32 v10, 7, v1
    v_lshl_add_u32 v11, v10, 4, v11
    s_lshl_b32 s15, s4, 19
    s_lshl_b32 s7, s74, 17
    s_add_u32 s15, s15, s7
    s_lshl_b32 s7, s72, 1
    s_add_u32 s7, s7, s73
    s_xor_b32 s7, s7, 4
    s_lshl_b32 s7, s7, 7
    s_add_u32 s15, s15, s7
    s_lshl_b32 s7, s74, 14
    s_add_u32 s7, s7, 16384
    s_mov_b32 m0, s7
    s_nop 0
    buffer_load_dwordx4 v11, s[52:55], s15 offen nt lds
    s_add_u32 s7, s7, 1024
    s_add_u32 s15, s15, 8192
    s_mov_b32 m0, s7
    s_nop 0
    buffer_load_dwordx4 v11, s[52:55], s15 offen nt lds
    s_add_u32 s7, s7, 1024
    s_add_u32 s15, s15, 8192
    s_mov_b32 m0, s7
    s_nop 0
    buffer_load_dwordx4 v11, s[52:55], s15 offen nt lds
    s_add_u32 s7, s7, 1024
    s_add_u32 s15, s15, 8192
    s_mov_b32 m0, s7
    s_nop 0
    buffer_load_dwordx4 v11, s[52:55], s15 offen nt lds
    s_add_u32 s7, s7, 1024
    s_add_u32 s15, s15, 8192
    s_mov_b32 m0, s7
    s_nop 0
    buffer_load_dwordx4 v11, s[52:55], s15 offen nt lds
    s_add_u32 s7, s7, 1024
    s_add_u32 s15, s15, 8192
    s_mov_b32 m0, s7
    s_nop 0
    buffer_load_dwordx4 v11, s[52:55], s15 offen nt lds
    s_add_u32 s7, s7, 1024
    s_add_u32 s15, s15, 8192
    s_mov_b32 m0, s7
    s_nop 0
    buffer_load_dwordx4 v11, s[52:55], s15 offen nt lds
    s_add_u32 s7, s7, 1024
    s_add_u32 s15, s15, 8192
    s_mov_b32 m0, s7
    s_nop 0
    buffer_load_dwordx4 v11, s[52:55], s15 offen nt lds
    s_add_u32 s7, s7, 1024
    s_add_u32 s15, s15, 8192
    s_mov_b32 m0, s7
    s_nop 0
    buffer_load_dwordx4 v11, s[52:55], s15 offen nt lds
    s_add_u32 s7, s7, 1024
    s_add_u32 s15, s15, 8192
    s_mov_b32 m0, s7
    s_nop 0
    buffer_load_dwordx4 v11, s[52:55], s15 offen nt lds
    s_add_u32 s7, s7, 1024
    s_add_u32 s15, s15, 8192
    s_mov_b32 m0, s7
    s_nop 0
    buffer_load_dwordx4 v11, s[52:55], s15 offen nt lds
    s_add_u32 s7, s7, 1024
    s_add_u32 s15, s15, 8192
    s_mov_b32 m0, s7
    s_nop 0
    buffer_load_dwordx4 v11, s[52:55], s15 offen nt lds
    s_add_u32 s7, s7, 1024
    s_add_u32 s15, s15, 8192
    s_mov_b32 m0, s7
    s_nop 0
    buffer_load_dwordx4 v11, s[52:55], s15 offen nt lds
    s_add_u32 s7, s7, 1024
    s_add_u32 s15, s15, 8192
    s_mov_b32 m0, s7
    s_nop 0
    buffer_load_dwordx4 v11, s[52:55], s15 offen nt lds
    s_add_u32 s7, s7, 1024
    s_add_u32 s15, s15, 8192
    s_mov_b32 m0, s7
    s_nop 0
    buffer_load_dwordx4 v11, s[52:55], s15 offen nt lds
    s_add_u32 s7, s7, 1024
    s_add_u32 s15, s15, 8192
    s_mov_b32 m0, s7
    s_nop 0
    buffer_load_dwordx4 v11, s[52:55], s15 offen nt lds
    s_branch L_wret
L_guload:
    s_sub_u32 s74, s3, 12
    s_lshl_b32 s7, s72, 1
    s_add_u32 s7, s7, s73
    s_sub_u32 s7, s7, 2
    s_cmp_ge_u32 s7, 7
    s_cbranch_scc1 L_wret
    s_mul_i32 s15, s4, 7
    s_add_u32 s15, s15, s7
    s_lshl_b32 s15, s15, 6
    s_mul_i32 s7, s74, 458752
    s_add_u32 s15, s15, s7
    v_lshrrev_b32 v10, 2, v1
    v_mul_u32_u24 v10, 3584, v10
    v_and_b32 v11, 3, v1
    v_lshl_add_u32 v10, v11, 4, v10
    s_lshl_b32 s74, s74, 14
    s_add_u32 s74, s74, 16384
    s_mov_b32 s52, s28
    s_mov_b32 s53, s29
    s_mov_b32 s54, 0x1c0000
    s_mov_b32 s55, 0x20000
    s_mov_b32 s56, s30
    s_mov_b32 s57, s31
    s_mov_b32 s58, 0x1c0000
    s_mov_b32 s59, 0x20000
    s_add_u32 s7, s74, 0
    s_mov_b32 m0, s7
    s_nop 0
    buffer_load_dwordx4 v10, s[52:55], s15 offen lds
    s_add_u32 s7, s74, 4096
    s_mov_b32 m0, s7
    s_nop 0
    buffer_load_dwordx4 v10, s[56:59], s15 offen lds
    s_add_u32 s15, s15, 57344
    s_add_u32 s7, s74, 1024
    s_mov_b32 m0, s7
    s_nop 0
    buffer_load_dwordx4 v10, s[52:55], s15 offen lds
    s_add_u32 s7, s74, 5120
    s_mov_b32 m0, s7
    s_nop 0
    buffer_load_dwordx4 v10, s[56:59], s15 offen lds
    s_add_u32 s15, s15, 57344
    s_add_u32 s7, s74, 2048
    s_mov_b32 m0, s7
    s_nop 0
    buffer_load_dwordx4 v10, s[52:55], s15 offen lds
    s_add_u32 s7, s74, 6144
    s_mov_b32 m0, s7
    s_nop 0
    buffer_load_dwordx4 v10, s[56:59], s15 offen lds
    s_add_u32 s15, s15, 57344
    s_add_u32 s7, s74, 3072
    s_mov_b32 m0, s7
    s_nop 0
    buffer_load_dwordx4 v10, s[52:55], s15 offen lds
    s_add_u32 s7, s74, 7168
    s_mov_b32 m0, s7
    s_nop 0
    buffer_load_dwordx4 v10, s[56:59], s15 offen lds
    s_add_u32 s15, s15, 57344
    s_add_u32 s7, s74, 8192
    s_mov_b32 m0, s7
    s_nop 0
    buffer_load_dwordx4 v10, s[52:55], s15 offen lds
    s_add_u32 s7, s74, 12288
    s_mov_b32 m0, s7
    s_nop 0
    buffer_load_dwordx4 v10, s[56:59], s15 offen lds
    s_add_u32 s15, s15, 57344
    s_add_u32 s7, s74, 9216
    s_mov_b32 m0, s7
    s_nop 0
    buffer_load_dwordx4 v10, s[52:55], s15 offen lds
    s_add_u32 s7, s74, 13312
    s_mov_b32 m0, s7
    s_nop 0
    buffer_load_dwordx4 v10, s[56:59], s15 offen lds
    s_add_u32 s15, s15, 57344
    s_add_u32 s7, s74, 10240
    s_mov_b32 m0, s7
    s_nop 0
    buffer_load_dwordx4 v10, s[52:55], s15 offen lds
    s_add_u32 s7, s74, 14336
    s_mov_b32 m0, s7
    s_nop 0
    buffer_load_dwordx4 v10, s[56:59], s15 offen lds
    s_add_u32 s15, s15, 57344
    s_add_u32 s7, s74, 11264
    s_mov_b32 m0, s7
    s_nop 0
    buffer_load_dwordx4 v10, s[52:55], s15 offen lds
    s_add_u32 s7, s74, 15360
    s_mov_b32 m0, s7
    s_nop 0
    buffer_load_dwordx4 v10, s[56:59], s15 offen lds
    s_mov_b32 s52, s32
    s_mov_b32 s53, s33
    s_mov_b32 s54, 0x1c0000
    s_mov_b32 s55, 0x20000
    s_lshl_b32 s7, s72, 1
    s_add_u32 s7, s7, s73
    s_sub_u32 s7, s7, 2
    s_mul_i32 s15, s4, 7
    s_add_u32 s15, s15, s7
    s_lshl_b32 s15, s15, 15
    s_sub_u32 s74, s3, 12
    s_lshl_b32 s7, s74, 13
    s_add_u32 s15, s15, s7
    s_mul_i32 s7, s74, 8448
    s_add_u32 s7, s7, 114688
    s_mov_b32 m0, s7
    s_nop 0
    buffer_load_dwordx4 v3, s[52:55], s15 offen lds
    s_add_u32 s7, s7, 1056
    s_add_u32 s15, s15, 1024
    s_mov_b32 m0, s7
    s_nop 0
    buffer_load_dwordx4 v3, s[52:55], s15 offen lds
    s_add_u32 s7, s7, 1056
    s_add_u32 s15, s15, 1024
    s_mov_b32 m0, s7
    s_nop 0
    buffer_load_dwordx4 v3, s[52:55], s15 offen lds
    s_add_u32 s7, s7, 1056
    s_add_u32 s15, s15, 1024
    s_mov_b32 m0, s7
    s_nop 0
    buffer_load_dwordx4 v3, s[52:55], s15 offen lds
    s_add_u32 s7, s7, 1056
    s_add_u32 s15, s15, 1024
    s_mov_b32 m0, s7
    s_nop 0
    buffer_load_dwordx4 v3, s[52:55], s15 offen lds
    s_add_u32 s7, s7, 1056
    s_add_u32 s15, s15, 1024
    s_mov_b32 m0, s7
    s_nop 0
    buffer_load_dwordx4 v3, s[52:55], s15 offen lds
    s_add_u32 s7, s7, 1056
    s_add_u32 s15, s15, 1024
    s_mov_b32 m0, s7
    s_nop 0
    buffer_load_dwordx4 v3, s[52:55], s15 offen lds
    s_add_u32 s7, s7, 1056
    s_add_u32 s15, s15, 1024
    s_mov_b32 m0, s7
    s_nop 0
    buffer_load_dwordx4 v3, s[52:55], s15 offen lds
L_wret:
    s_setpc_b64 s[76:77]
L_helper:
    s_setprio 3
L_helper2:
    v_lshrrev_b32 v13, 4, v1
    v_bfe_u32 v14, v1, 2, 2
    v_and_b32 v11, 3, v1
    v_lshlrev_b32 v10, 13, v11
    v_lshl_add_u32 v10, v14, 6, v10
    v_lshl_add_u32 v10, v13, 4, v10
    s_lshl_b32 s15, s4, 15
    s_lshl_b32 s7, s72, 11
    s_add_u32 s15, s15, s7
    s_lshl_b32 s7, s73, 8
    s_add_u32 s15, s15, s7
    s_add_u32 s15, s15, 655360
    s_add_u32 s74, s15, 786432
    s_waitcnt vmcnt(0)
    v_lshlrev_b32 v32, 16, v16
    v_and_b32 v33, s68, v16
    v_lshlrev_b32 v34, 16, v17
    v_and_b32 v35, s68, v17
    v_lshlrev_b32 v36, 16, v18
    v_and_b32 v37, s68, v18
    v_lshlrev_b32 v38, 16, v19
    v_and_b32 v39, s68, v19
    v_lshlrev_b32 v40, 16, v20
    v_and_b32 v41, s68, v20
    v_lshlrev_b32 v42, 16, v21
    v_and_b32 v43, s68, v21
    v_lshlrev_b32 v44, 16, v22
    v_and_b32 v45, s68, v22
    v_lshlrev_b32 v46, 16, v23
    v_and_b32 v47, s68, v23
    v_lshlrev_b32 v48, 16, v24
    v_and_b32 v49, s68, v24
    v_lshlrev_b32 v50, 16, v25
    v_and_b32 v51, s68, v25
    v_lshlrev_b32 v52, 16, v26
    v_and_b32 v53, s68, v26
    v_lshlrev_b32 v54, 16, v27
    v_and_b32 v55, s68, v27
    v_lshlrev_b32 v56, 16, v28
    v_and_b32 v57, s68, v28
    v_lshlrev_b32 v58, 16, v29
    v_and_b32 v59, s68, v29
    v_lshlrev_b32 v60, 16, v30
    v_and_b32 v61, s68, v30
    v_lshlrev_b32 v62, 16, v31
    v_and_b32 v63, s68, v31
    v_pk_add_f32 v[64:65], v[32:33], v[34:35]
    v_pk_add_f32 v[66:67], v[36:37], v[38:39]
    v_pk_add_f32 v[64:65], v[64:65], v[40:41]
    v_pk_add_f32 v[66:67], v[66:67], v[42:43]
    v_pk_add_f32 v[64:65], v[64:65], v[44:45]
    v_pk_add_f32 v[66:67], v[66:67], v[46:47]
    v_pk_add_f32 v[64:65], v[64:65], v[48:49]
    v_pk_add_f32 v[66:67], v[66:67], v[50:51]
    v_pk_add_f32 v[64:65], v[64:65], v[52:53]
    v_pk_add_f32 v[66:67], v[66:67], v[54:55]
    v_pk_add_f32 v[64:65], v[64:65], v[56:57]
    v_pk_add_f32 v[66:67], v[66:67], v[58:59]
    v_pk_add_f32 v[64:65], v[64:65], v[60:61]
    v_pk_add_f32 v[66:67], v[66:67], v[62:63]
    v_pk_add_f32 v[64:65], v[64:65], v[66:67]
    v_add_f32 v64, v64, v65
    s_nop 1
    v_add_f32_dpp v64, v64, v64 row_ror:1 row_mask:0xf bank_mask:0xf
    s_nop 1
    v_add_f32_dpp v64, v64, v64 row_ror:2 row_mask:0xf bank_mask:0xf
    s_nop 1
    v_add_f32_dpp v64, v64, v64 row_ror:4 row_mask:0xf bank_mask:0xf
    s_nop 1
    v_add_f32_dpp v64, v64, v64 row_ror:8 row_mask:0xf bank_mask:0xf
    v_mul_f32 v64, 0xbb000000, v64
    v_mov_b32 v65, v64
    v_pk_add_f32 v[32:33], v[32:33], v[64:65]
    v_pk_add_f32 v[34:35], v[34:35], v[64:65]
    v_pk_add_f32 v[36:37], v[36:37], v[64:65]
    v_pk_add_f32 v[38:39], v[38:39], v[64:65]
    v_pk_add_f32 v[40:41], v[40:41], v[64:65]
    v_pk_add_f32 v[42:43], v[42:43], v[64:65]
    v_pk_add_f32 v[44:45], v[44:45], v[64:65]
    v_pk_add_f32 v[46:47], v[46:47], v[64:65]
    v_pk_add_f32 v[48:49], v[48:49], v[64:65]
    v_pk_add_f32 v[50:51], v[50:51], v[64:65]
    v_pk_add_f32 v[52:53], v[52:53], v[64:65]
    v_pk_add_f32 v[54:55], v[54:55], v[64:65]
    v_pk_add_f32 v[56:57], v[56:57], v[64:65]
    v_pk_add_f32 v[58:59], v[58:59], v[64:65]
    v_pk_add_f32 v[60:61], v[60:61], v[64:65]
    v_pk_add_f32 v[62:63], v[62:63], v[64:65]
    v_pk_mul_f32 v[66:67], v[32:33], v[32:33]
    v_pk_mul_f32 v[68:69], v[34:35], v[34:35]
    v_pk_fma_f32 v[66:67], v[36:37], v[36:37], v[66:67]
    v_pk_fma_f32 v[68:69], v[38:39], v[38:39], v[68:69]
    v_pk_fma_f32 v[66:67], v[40:41], v[40:41], v[66:67]
    v_pk_fma_f32 v[68:69], v[42:43], v[42:43], v[68:69]
    v_pk_fma_f32 v[66:67], v[44:45], v[44:45], v[66:67]
    v_pk_fma_f32 v[68:69], v[46:47], v[46:47], v[68:69]
    v_pk_fma_f32 v[66:67], v[48:49], v[48:49], v[66:67]
    v_pk_fma_f32 v[68:69], v[50:51], v[50:51], v[68:69]
    v_pk_fma_f32 v[66:67], v[52:53], v[52:53], v[66:67]
    v_pk_fma_f32 v[68:69], v[54:55], v[54:55], v[68:69]
    v_pk_fma_f32 v[66:67], v[56:57], v[56:57], v[66:67]
    v_pk_fma_f32 v[68:69], v[58:59], v[58:59], v[68:69]
    v_pk_fma_f32 v[66:67], v[60:61], v[60:61], v[66:67]
    v_pk_fma_f32 v[68:69], v[62:63], v[62:63], v[68:69]
    v_pk_add_f32 v[66:67], v[66:67], v[68:69]
    v_add_f32 v66, v66, v67
    s_nop 1
    v_add_f32_dpp v66, v66, v66 row_ror:1 row_mask:0xf bank_mask:0xf
    s_nop 1
    v_add_f32_dpp v66, v66, v66 row_ror:2 row_mask:0xf bank_mask:0xf
    s_nop 1
    v_add_f32_dpp v66, v66, v66 row_ror:4 row_mask:0xf bank_mask:0xf
    s_nop 1
    v_add_f32_dpp v66, v66, v66 row_ror:8 row_mask:0xf bank_mask:0xf
    v_lshlrev_b32 v32, 16, v72
    v_and_b32 v33, s68, v72
    v_lshlrev_b32 v34, 16, v73
    v_and_b32 v35, s68, v73
    v_lshlrev_b32 v36, 16, v74
    v_and_b32 v37, s68, v74
    v_lshlrev_b32 v38, 16, v75
    v_and_b32 v39, s68, v75
    v_mul_f32 v66, 0x3b000000, v66
    v_cvt_pk_bf16_f32 v64, v64, v66
    v_and_b32 v66, s68, v64
    v_lshlrev_b32 v64, 16, v64
    v_add_f32 v66, 0x3727c5ac, v66
    v_cvt_pk_bf16_f32 v66, v66, v66
    v_and_b32 v66, s68, v66
    v_sqrt_f32 v66, v66
    v_add_f32 v32, v32, v64
    v_add_f32 v33, v33, v64
    v_add_f32 v34, v34, v64
    v_add_f32 v35, v35, v64
    v_add_f32 v36, v36, v64
    v_add_f32 v37, v37, v64
    v_add_f32 v38, v38, v64
    v_add_f32 v39, v39, v64
    v_cvt_pk_bf16_f32 v66, v66, v66
    v_and_b32 v66, s68, v66
    v_rcp_f32 v66, v66
    v_cvt_pk_bf16_f32 v16, v32, v33
    v_cvt_pk_bf16_f32 v17, v34, v35
    v_cvt_pk_bf16_f32 v18, v36, v37
    v_cvt_pk_bf16_f32 v19, v38, v39
    v_lshlrev_b32 v32, 16, v16
    v_and_b32 v33, s68, v16
    v_lshlrev_b32 v34, 16, v17
    v_and_b32 v35, s68, v17
    v_lshlrev_b32 v36, 16, v18
    v_and_b32 v37, s68, v18
    v_lshlrev_b32 v38, 16, v19
    v_and_b32 v39, s68, v19
    v_mul_f32 v32, v32, v66
    v_mul_f32 v33, v33, v66
    v_mul_f32 v34, v34, v66
    v_mul_f32 v35, v35, v66
    v_mul_f32 v36, v36, v66
    v_mul_f32 v37, v37, v66
    v_mul_f32 v38, v38, v66
    v_mul_f32 v39, v39, v66
    v_cvt_pk_bf16_f32 v16, v32, v33
    v_cvt_pk_bf16_f32 v17, v34, v35
    v_cvt_pk_bf16_f32 v18, v36, v37
    v_cvt_pk_bf16_f32 v19, v38, v39
    ds_write_b128 v3, v[16:19] offset:2048
    v_lshlrev_b32 v12, 10, v13
    v_lshl_add_u32 v12, v14, 7, v12
    v_lshl_add_u32 v12, v11, 3, v12
    v_add_u32 v12, 114688, v12
    v_lshlrev_b32 v13, 4, v13
    v_lshl_add_u32 v13, v11, 8, v13
    s_waitcnt lgkmcnt(0)
    ds_read_b128 v[80:83], v13 offset:2048
    ds_read_b128 v[84:87], v13 offset:2112
    ds_read_b128 v[88:91], v13 offset:2176
    ds_read_b128 v[92:95], v13 offset:2240
    s_mov_b32 s64, s6
L_tagok_h:
    s_mul_i32 s64, s64, 0x9E3779B1
    s_add_u32 s64, s64, 0x7F4A7C15
    s_and_b32 s8, s64, 0xff
    s_bfe_u32 s9, s64, 0x80008
    s_cmp_eq_u32 s8, s9
    s_cbranch_scc1 L_tagok_h
    s_bfe_u32 s10, s64, 0x80010
    s_lshr_b32 s11, s64, 24
    s_xor_b32 s75, s11, s79
    s_mov_b32 s70, 0
L_lw20:
    ds_read_b32 v104, v0 offset:28
    s_add_u32 s70, s70, 1
    s_waitcnt lgkmcnt(0)
    v_readfirstlane_b32 s7, v104
    s_nop 0
    s_cmp_eq_u32 s7, 4
    s_cbranch_scc1 L_lwd20
    s_cmp_lt_u32 s70, 262144
    s_cbranch_scc1 L_lw20
L_lwd20:
L_hnw:
    ds_read_b64_tr_b16 v[16:17], v12 offset:0
    ds_read_b64_tr_b16 v[18:19], v12 offset:512
    ds_read_b64_tr_b16 v[20:21], v12 offset:32
    ds_read_b64_tr_b16 v[22:23], v12 offset:544
    ds_read_b64_tr_b16 v[24:25], v12 offset:64
    ds_read_b64_tr_b16 v[26:27], v12 offset:576
    ds_read_b64_tr_b16 v[28:29], v12 offset:96
    ds_read_b64_tr_b16 v[30:31], v12 offset:608
    s_waitcnt lgkmcnt(6)
    v_mfma_f32_16x16x32_bf16 v[32:35], v[16:19], v[80:83], 0
    s_waitcnt lgkmcnt(4)
    v_mfma_f32_16x16x32_bf16 v[36:39], v[20:23], v[80:83], 0
    s_waitcnt lgkmcnt(2)
    v_mfma_f32_16x16x32_bf16 v[40:43], v[24:27], v[80:83], 0
    s_waitcnt lgkmcnt(0)
    v_mfma_f32_16x16x32_bf16 v[44:47], v[28:31], v[80:83], 0
    ds_read_b64_tr_b16 v[16:17], v12 offset:4096
    ds_read_b64_tr_b16 v[18:19], v12 offset:4608
    ds_read_b64_tr_b16 v[20:21], v12 offset:4128
    ds_read_b64_tr_b16 v[22:23], v12 offset:4640
    ds_read_b64_tr_b16 v[24:25], v12 offset:4160
    ds_read_b64_tr_b16 v[26:27], v12 offset:4672
    ds_read_b64_tr_b16 v[28:29], v12 offset:4192
    ds_read_b64_tr_b16 v[30:31], v12 offset:4704
    s_waitcnt lgkmcnt(6)
    v_mfma_f32_16x16x32_bf16 v[32:35], v[16:19], v[84:87], v[32:35]
    s_waitcnt lgkmcnt(4)
    v_mfma_f32_16x16x32_bf16 v[36:39], v[20:23], v[84:87], v[36:39]
    s_waitcnt lgkmcnt(2)
    v_mfma_f32_16x16x32_bf16 v[40:43], v[24:27], v[84:87], v[40:43]
    s_waitcnt lgkmcnt(0)
    v_mfma_f32_16x16x32_bf16 v[44:47], v[28:31], v[84:87], v[44:47]
    ds_read_b64_tr_b16 v[16:17], v12 offset:8192
    ds_read_b64_tr_b16 v[18:19], v12 offset:8704
    ds_read_b64_tr_b16 v[20:21], v12 offset:8224
    ds_read_b64_tr_b16 v[22:23], v12 offset:8736
    ds_read_b64_tr_b16 v[24:25], v12 offset:8256
    ds_read_b64_tr_b16 v[26:27], v12 offset:8768
    ds_read_b64_tr_b16 v[28:29], v12 offset:8288
    ds_read_b64_tr_b16 v[30:31], v12 offset:8800
    s_waitcnt lgkmcnt(6)
    v_mfma_f32_16x16x32_bf16 v[32:35], v[16:19], v[88:91], v[32:35]
    s_waitcnt lgkmcnt(4)
    v_mfma_f32_16x16x32_bf16 v[36:39], v[20:23], v[88:91], v[36:39]
    s_waitcnt lgkmcnt(2)
    v_mfma_f32_16x16x32_bf16 v[40:43], v[24:27], v[88:91], v[40:43]
    s_waitcnt lgkmcnt(0)
    v_mfma_f32_16x16x32_bf16 v[44:47], v[28:31], v[88:91], v[44:47]
    ds_read_b64_tr_b16 v[16:17], v12 offset:12288
    ds_read_b64_tr_b16 v[18:19], v12 offset:12800
    ds_read_b64_tr_b16 v[20:21], v12 offset:12320
    ds_read_b64_tr_b16 v[22:23], v12 offset:12832
    ds_read_b64_tr_b16 v[24:25], v12 offset:12352
    ds_read_b64_tr_b16 v[26:27], v12 offset:12864
    ds_read_b64_tr_b16 v[28:29], v12 offset:12384
    ds_read_b64_tr_b16 v[30:31], v12 offset:12896
    s_waitcnt lgkmcnt(6)
    v_mfma_f32_16x16x32_bf16 v[32:35], v[16:19], v[92:95], v[32:35]
    s_waitcnt lgkmcnt(4)
    v_mfma_f32_16x16x32_bf16 v[36:39], v[20:23], v[92:95], v[36:39]
    s_waitcnt lgkmcnt(2)
    v_mfma_f32_16x16x32_bf16 v[40:43], v[24:27], v[92:95], v[40:43]
    s_waitcnt lgkmcnt(0)
    v_mfma_f32_16x16x32_bf16 v[44:47], v[28:31], v[92:95], v[44:47]
    s_mov_b32 exec_lo, 0xf000f0
    s_mov_b32 exec_hi, 0xf000f0
    s_nop 1
    v_mov_b32 v32, v36
    v_mov_b32 v33, v37
    v_mov_b32 v34, v38
    v_mov_b32 v35, v39
    s_mov_b32 exec_lo, 0xf000f00
    s_mov_b32 exec_hi, 0xf000f00
    v_mov_b32 v32, v40
    v_mov_b32 v33, v41
    v_mov_b32 v34, v42
    v_mov_b32 v35, v43
    s_mov_b32 exec_lo, 0xf000f000
    s_mov_b32 exec_hi, 0xf000f000
    v_mov_b32 v32, v44
    v_mov_b32 v33, v45
    v_mov_b32 v34, v46
    v_mov_b32 v35, v47
    s_mov_b64 exec, -1
    v_add_u32 v100, 0x80, v32
    v_and_b32 v100, s67, v100
    v_or_b32 v100, s8, v100
    v_add_u32 v101, 0x80, v33
    v_and_b32 v101, s67, v101
    v_or_b32 v101, s9, v101
    v_add_u32 v102, 0x80, v34
    v_and_b32 v102, s67, v102
    v_or_b32 v102, s10, v102
    v_add_u32 v103, 0x80, v35
    v_and_b32 v103, s67, v103
    v_or_b32 v103, s75, v103
    buffer_store_dwordx4 v[100:103], v10, s[48:51], s74 offen
    buffer_store_dwordx4 v[100:103], v10, s[48:51], s15 offen sc1
    v_mov_b32 v11, 1
    ds_write_b32 v0, v11 offset:4
    s_setprio 1
    s_branch L_loads
L_fin:
L_end:
    s_endpgm
.section .rodata,"a"
.p2align 6
.amdhsa_kernel sequential_preLN__gqa_block_cached__swiglu_ffn__decode_kernel
  .amdhsa_next_free_vgpr 128
  .amdhsa_next_free_sgpr 102
  .amdhsa_accum_offset 128
  .amdhsa_group_segment_fixed_size 0
  .amdhsa_kernarg_size 96
  .amdhsa_user_sgpr_count 2
  .amdhsa_user_sgpr_kernarg_segment_ptr 1
  .amdhsa_system_sgpr_workgroup_id_x 1
  .amdhsa_float_denorm_mode_32 3
.end_amdhsa_kernel
```
